```python
import torch

def _softmax(x, axis=-1):
    return torch.softmax(x, dim=axis)
def _gelu(x):
    return torch.nn.functional.gelu(x, approximate="tanh")
def _silu(x):
    return torch.nn.functional.silu(x)
def _sigmoid(x):
    return torch.sigmoid(x)
def _layernorm(x, axis=-1, eps=1e-5):
    m = x.mean(dim=axis, keepdim=True)
    v = x.var(dim=axis, keepdim=True, unbiased=False)
    return (x - m) / torch.sqrt(v + eps)
def _scatter_add(tgt, idx, src, axis=0):
    return tgt.clone().index_add_(axis, idx, src)
def _segment_sum(src, seg, n):
    out = torch.zeros((n,) + src.shape[1:], dtype=src.dtype)
    return out.index_add_(0, seg, src)
def _pad(x, pw):
    flat = tuple(v for pair in reversed(pw) for v in pair)
    return torch.nn.functional.pad(x, flat)

kernel_name = 'parallel_sum__spectral_gfnet__glu_gated_geglu__prompt'

def setup_inputs():

    _w = (lambda a: (lambda t: t.to(torch.bfloat16) if t.is_floating_point() else t)(torch.as_tensor(a)))
    def _A_setup():
        B, S, D = 1, 2048, 576
        Df = D // 2 + 1
        return {
            "x": _w((lambda *s: torch.randn(*s, dtype=torch.bfloat16) * 0.05)(B, S, D)),
            "w_r": _w((lambda *s: torch.randn(*s, dtype=torch.bfloat16) * 0.8)(S, Df) * 0.02),
            "w_i": _w((lambda *s: torch.randn(*s, dtype=torch.bfloat16) * 0.8)(S, Df) * 0.02),
        }
    _A_in = _A_setup()

    def _B_setup():
        B, S, Dm, Df = 1, 2048, 576, 4608
        return {
            "x": _w((lambda *s: torch.randn(*s, dtype=torch.bfloat16) * 0.05)(B, S, Dm)),
            "w_gate": _w((lambda *s: torch.randn(*s, dtype=torch.bfloat16) * 0.4)(Dm, Df) * (Dm ** -0.5)),
            "w_up": _w((lambda *s: torch.randn(*s, dtype=torch.bfloat16) * 0.4)(Dm, Df) * (Dm ** -0.5)),
            "w_down": _w((lambda *s: torch.randn(*s, dtype=torch.bfloat16) * 0.4)(Df, Dm) * (Df ** -0.5)),
        }
    _B_in = _B_setup()

    return {
        "A_x": _A_in["x"],
        "A_w_r": _A_in["w_r"],
        "A_w_i": _A_in["w_i"],
        "B_x": _B_in["x"],
        "B_w_gate": _B_in["w_gate"],
        "B_w_up": _B_in["w_up"],
        "B_w_down": _B_in["w_down"],
    }

def reference(A_x, A_w_r, A_w_i, B_x, B_w_gate, B_w_up, B_w_down):
    def _A_ref(x, w_r, w_i):
        B, S, D = x.shape
        X = (lambda x, axes=(-2,-1): torch.fft.rfft2(x.float(), dim=axes))(x, axes=(-2, -1))
        W = w_r + 1j * w_i
        X = X * W
        y = (lambda x, s, axes=(-2,-1): torch.fft.irfft2(x, s=s, dim=axes).to(torch.bfloat16))(X, (S, D), axes=(-2, -1))
        return y

    def _B_ref(x, w_gate, w_up, w_down):
        g = torch.einsum("bsd,df->bsf", x, w_gate)
        u = torch.einsum("bsd,df->bsf", x, w_up)
        h = _gelu(g) * u
        return torch.einsum("bsf,fd->bsd", h, w_down)

    x = A_x
    xn = _layernorm(x, axis=-1)
    return x + _A_ref(xn, A_w_r, A_w_i) + _B_ref(xn, B_w_gate, B_w_up, B_w_down)
```

```asm
; @launch kernel=k0_kernel grid=(256,1,1) block=(512,1,1) lds=106496
; @launch kernel=k1_kernel grid=(256,1,1) block=(512,1,1) lds=140288
; @launch kernel=k2_kernel grid=(330,1,1) block=(512,1,1) lds=79872
; @launch kernel=k3_kernel grid=(576,1,1) block=(256,1,1) lds=32768
.amdgcn_target "amdgcn-amd-amdhsa--gfx950"
.text
.globl k0_kernel
.p2align 8
.type k0_kernel,@function
k0_kernel:
    s_cmp_ge_u32 s2, 256
    s_cbranch_scc1 K0_END
    s_load_dwordx2 s[4:5], s[0:1], 0
    s_load_dwordx2 s[6:7], s[0:1], 72
    s_load_dwordx4 s[20:23], s[0:1], 8
    s_load_dwordx2 s[44:45], s[0:1], 32
    s_load_dwordx2 s[48:49], s[0:1], 40
    s_load_dwordx2 s[52:53], s[0:1], 48
    v_lshrrev_b32 v1, 6, v0
    v_and_b32 v2, 63, v0
    s_nop 0
    v_readfirstlane_b32 s3, v1
    v_and_b32 v3, 31, v2
    v_lshrrev_b32 v4, 5, v2
    s_mov_b32 s30, 0x3ae38e39
    s_mov_b32 s31, 0xc4100000
    s_waitcnt lgkmcnt(0)
    s_mov_b32 s8, s6
    s_mov_b32 s9, s7
    s_mov_b32 s10, 268435456
    s_mov_b32 s11, 0x00020000
    s_mov_b32 s12, s4
    s_mov_b32 s13, s5
    s_mov_b32 s14, 2359296
    s_mov_b32 s15, 0x00020000
    s_cmp_ge_u32 s2, 224
    s_cbranch_scc1 K0_WT
    s_and_b32 s24, s2, 31
    s_lshr_b32 s25, s2, 5
    s_and_b32 s26, s3, 1
    s_lshr_b32 s27, s3, 1
    s_lshl_b32 s28, s24, 1
    s_add_u32 s28, s28, s26
    s_lshl_b32 s29, s28, 5
    v_add_u32 v5, s29, v3
    v_mul_u32_u24 v5, 1152, v5
    v_lshl_add_u32 v5, v4, 4, v5
    s_mul_i32 s33, s27, 288
    s_lshl_b32 s34, s24, 6
    s_lshl_b32 s35, s3, 3
    s_add_u32 s34, s34, s35
    s_mul_i32 s34, s34, 1152
    s_mul_i32 s35, s35, 1168
    v_lshlrev_b32 v5, 4, v2
    s_mov_b32 exec_hi, 15
    s_add_u32 m0, s35, 0
    s_add_u32 s36, s34, 0
    buffer_load_dwordx4 v5, s[12:15], s36 offen lds
    s_add_u32 m0, s35, 576
    s_add_u32 s36, s34, 576
    buffer_load_dwordx4 v5, s[12:15], s36 offen lds
    s_add_u32 m0, s35, 1168
    s_add_u32 s36, s34, 1152
    buffer_load_dwordx4 v5, s[12:15], s36 offen lds
    s_add_u32 m0, s35, 1744
    s_add_u32 s36, s34, 1728
    buffer_load_dwordx4 v5, s[12:15], s36 offen lds
    s_add_u32 m0, s35, 2336
    s_add_u32 s36, s34, 2304
    buffer_load_dwordx4 v5, s[12:15], s36 offen lds
    s_add_u32 m0, s35, 2912
    s_add_u32 s36, s34, 2880
    buffer_load_dwordx4 v5, s[12:15], s36 offen lds
    s_add_u32 m0, s35, 3504
    s_add_u32 s36, s34, 3456
    buffer_load_dwordx4 v5, s[12:15], s36 offen lds
    s_add_u32 m0, s35, 4080
    s_add_u32 s36, s34, 4032
    buffer_load_dwordx4 v5, s[12:15], s36 offen lds
    s_add_u32 m0, s35, 4672
    s_add_u32 s36, s34, 4608
    buffer_load_dwordx4 v5, s[12:15], s36 offen lds
    s_add_u32 m0, s35, 5248
    s_add_u32 s36, s34, 5184
    buffer_load_dwordx4 v5, s[12:15], s36 offen lds
    s_add_u32 m0, s35, 5840
    s_add_u32 s36, s34, 5760
    buffer_load_dwordx4 v5, s[12:15], s36 offen lds
    s_add_u32 m0, s35, 6416
    s_add_u32 s36, s34, 6336
    buffer_load_dwordx4 v5, s[12:15], s36 offen lds
    s_add_u32 m0, s35, 7008
    s_add_u32 s36, s34, 6912
    buffer_load_dwordx4 v5, s[12:15], s36 offen lds
    s_add_u32 m0, s35, 7584
    s_add_u32 s36, s34, 7488
    buffer_load_dwordx4 v5, s[12:15], s36 offen lds
    s_add_u32 m0, s35, 8176
    s_add_u32 s36, s34, 8064
    buffer_load_dwordx4 v5, s[12:15], s36 offen lds
    s_add_u32 m0, s35, 8752
    s_add_u32 s36, s34, 8640
    buffer_load_dwordx4 v5, s[12:15], s36 offen lds
    s_mov_b32 exec_hi, -1
    s_cmp_ge_u32 s3, 6
    s_cbranch_scc1 K0_LN
    s_mul_i32 s34, s25, 3
    s_add_u32 s34, s34, s27
    s_lshl_b32 s34, s34, 5
    v_add_u32 v6, s34, v3
    v_lshrrev_b32 v7, 1, v6
    v_and_b32 v8, 1, v6
    v_cvt_f32_u32 v9, v7
    v_cvt_f32_u32 v10, v8
    v_mul_f32 v10, 0.25, v10
    v_cmp_ge_u32 vcc, 288, v7
    v_mov_b32 v11, 1.0
    v_mov_b32 v12, 0
    v_cndmask_b32 v11, 0, v11, vcc
    v_mov_b32 v19, 0xbe800000
    v_mul_f32 v17, 0x41800000, v9
    s_mul_i32 s35, s26, 288
    v_lshlrev_b32 v15, 3, v4
    v_add_u32 v15, s35, v15
    v_cvt_f32_u32 v15, v15
    v_mul_f32 v16, v15, v9
    v_add_f32 v18, 0xbe800000, v10
    v_mul_f32 v14, s30, v9
    v_rndne_f32 v14, v14
    v_fma_f32 v14, s31, v14, v9
    v_fma_f32 v14, s30, v14, v12
    v_cos_f32 v13, v14
    v_mul_f32 v14, s30, v9
    v_rndne_f32 v14, v14
    v_fma_f32 v14, s31, v14, v9
    v_fma_f32 v14, s30, v14, v19
    v_cos_f32 v20, v14
    v_mul_f32 v14, s30, v17
    v_rndne_f32 v14, v14
    v_fma_f32 v14, s31, v14, v17
    v_fma_f32 v14, s30, v14, v12
    v_cos_f32 v21, v14
    v_mul_f32 v14, s30, v17
    v_rndne_f32 v14, v14
    v_fma_f32 v14, s31, v14, v17
    v_fma_f32 v14, s30, v14, v19
    v_cos_f32 v22, v14
    v_mul_f32 v14, s30, v16
    v_rndne_f32 v14, v14
    v_fma_f32 v14, s31, v14, v16
    v_fma_f32 v14, s30, v14, v10
    v_cos_f32 v23, v14
    v_mul_f32 v14, s30, v16
    v_rndne_f32 v14, v14
    v_fma_f32 v14, s31, v14, v16
    v_fma_f32 v14, s30, v14, v18
    v_cos_f32 v24, v14
    s_nop 0
    v_mul_f32 v23, v23, v11
    v_mul_f32 v24, v24, v11
    v_add_f32 v15, v13, v13
    v_mul_f32 v25, v23, v13
    v_mul_f32 v34, v23, v21
    v_fma_f32 v25, -v24, v20, v25
    v_mul_f32 v35, v24, v21
    v_fma_f32 v26, v15, v25, -v23
    v_fma_f32 v34, -v24, v22, v34
    v_fma_f32 v27, v15, v26, -v25
    v_fma_f32 v35, v23, v22, v35
    v_fma_f32 v28, v15, v27, -v26
    v_cvt_pk_bf16_f32 v172, v23, v25
    v_fma_f32 v29, v15, v28, -v27
    v_cvt_pk_bf16_f32 v173, v26, v27
    v_fma_f32 v30, v15, v29, -v28
    v_mov_b32 v23, v34
    v_fma_f32 v31, v15, v30, -v29
    v_mov_b32 v24, v35
    v_cvt_pk_bf16_f32 v174, v28, v29
    v_cvt_pk_bf16_f32 v175, v30, v31
    v_mul_f32 v25, v23, v13
    v_mul_f32 v34, v23, v21
    v_fma_f32 v25, -v24, v20, v25
    v_mul_f32 v35, v24, v21
    v_fma_f32 v26, v15, v25, -v23
    v_fma_f32 v34, -v24, v22, v34
    v_fma_f32 v27, v15, v26, -v25
    v_fma_f32 v35, v23, v22, v35
    v_fma_f32 v28, v15, v27, -v26
    v_cvt_pk_bf16_f32 v176, v23, v25
    v_fma_f32 v29, v15, v28, -v27
    v_cvt_pk_bf16_f32 v177, v26, v27
    v_fma_f32 v30, v15, v29, -v28
    v_mov_b32 v23, v34
    v_fma_f32 v31, v15, v30, -v29
    v_mov_b32 v24, v35
    v_cvt_pk_bf16_f32 v178, v28, v29
    v_cvt_pk_bf16_f32 v179, v30, v31
    v_mul_f32 v25, v23, v13
    v_mul_f32 v34, v23, v21
    v_fma_f32 v25, -v24, v20, v25
    v_mul_f32 v35, v24, v21
    v_fma_f32 v26, v15, v25, -v23
    v_fma_f32 v34, -v24, v22, v34
    v_fma_f32 v27, v15, v26, -v25
    v_fma_f32 v35, v23, v22, v35
    v_fma_f32 v28, v15, v27, -v26
    v_cvt_pk_bf16_f32 v180, v23, v25
    v_fma_f32 v29, v15, v28, -v27
    v_cvt_pk_bf16_f32 v181, v26, v27
    v_fma_f32 v30, v15, v29, -v28
    v_mov_b32 v23, v34
    v_fma_f32 v31, v15, v30, -v29
    v_mov_b32 v24, v35
    v_cvt_pk_bf16_f32 v182, v28, v29
    v_cvt_pk_bf16_f32 v183, v30, v31
    v_mul_f32 v25, v23, v13
    v_mul_f32 v34, v23, v21
    v_fma_f32 v25, -v24, v20, v25
    v_mul_f32 v35, v24, v21
    v_fma_f32 v26, v15, v25, -v23
    v_fma_f32 v34, -v24, v22, v34
    v_fma_f32 v27, v15, v26, -v25
    v_fma_f32 v35, v23, v22, v35
    v_fma_f32 v28, v15, v27, -v26
    v_cvt_pk_bf16_f32 v184, v23, v25
    v_fma_f32 v29, v15, v28, -v27
    v_cvt_pk_bf16_f32 v185, v26, v27
    v_fma_f32 v30, v15, v29, -v28
    v_mov_b32 v23, v34
    v_fma_f32 v31, v15, v30, -v29
    v_mov_b32 v24, v35
    v_cvt_pk_bf16_f32 v186, v28, v29
    v_cvt_pk_bf16_f32 v187, v30, v31
    v_mul_f32 v25, v23, v13
    v_mul_f32 v34, v23, v21
    v_fma_f32 v25, -v24, v20, v25
    v_mul_f32 v35, v24, v21
    v_fma_f32 v26, v15, v25, -v23
    v_fma_f32 v34, -v24, v22, v34
    v_fma_f32 v27, v15, v26, -v25
    v_fma_f32 v35, v23, v22, v35
    v_fma_f32 v28, v15, v27, -v26
    v_cvt_pk_bf16_f32 v188, v23, v25
    v_fma_f32 v29, v15, v28, -v27
    v_cvt_pk_bf16_f32 v189, v26, v27
    v_fma_f32 v30, v15, v29, -v28
    v_mov_b32 v23, v34
    v_fma_f32 v31, v15, v30, -v29
    v_mov_b32 v24, v35
    v_cvt_pk_bf16_f32 v190, v28, v29
    v_cvt_pk_bf16_f32 v191, v30, v31
    v_mul_f32 v25, v23, v13
    v_mul_f32 v34, v23, v21
    v_fma_f32 v25, -v24, v20, v25
    v_mul_f32 v35, v24, v21
    v_fma_f32 v26, v15, v25, -v23
    v_fma_f32 v34, -v24, v22, v34
    v_fma_f32 v27, v15, v26, -v25
    v_fma_f32 v35, v23, v22, v35
    v_fma_f32 v28, v15, v27, -v26
    v_cvt_pk_bf16_f32 v192, v23, v25
    v_fma_f32 v29, v15, v28, -v27
    v_cvt_pk_bf16_f32 v193, v26, v27
    v_fma_f32 v30, v15, v29, -v28
    v_mov_b32 v23, v34
    v_fma_f32 v31, v15, v30, -v29
    v_mov_b32 v24, v35
    v_cvt_pk_bf16_f32 v194, v28, v29
    v_cvt_pk_bf16_f32 v195, v30, v31
    v_mul_f32 v25, v23, v13
    v_mul_f32 v34, v23, v21
    v_fma_f32 v25, -v24, v20, v25
    v_mul_f32 v35, v24, v21
    v_fma_f32 v26, v15, v25, -v23
    v_fma_f32 v34, -v24, v22, v34
    v_fma_f32 v27, v15, v26, -v25
    v_fma_f32 v35, v23, v22, v35
    v_fma_f32 v28, v15, v27, -v26
    v_cvt_pk_bf16_f32 v196, v23, v25
    v_fma_f32 v29, v15, v28, -v27
    v_cvt_pk_bf16_f32 v197, v26, v27
    v_fma_f32 v30, v15, v29, -v28
    v_mov_b32 v23, v34
    v_fma_f32 v31, v15, v30, -v29
    v_mov_b32 v24, v35
    v_cvt_pk_bf16_f32 v198, v28, v29
    v_cvt_pk_bf16_f32 v199, v30, v31
    v_mul_f32 v25, v23, v13
    v_mul_f32 v34, v23, v21
    v_fma_f32 v25, -v24, v20, v25
    v_mul_f32 v35, v24, v21
    v_fma_f32 v26, v15, v25, -v23
    v_fma_f32 v34, -v24, v22, v34
    v_fma_f32 v27, v15, v26, -v25
    v_fma_f32 v35, v23, v22, v35
    v_fma_f32 v28, v15, v27, -v26
    v_cvt_pk_bf16_f32 v200, v23, v25
    v_fma_f32 v29, v15, v28, -v27
    v_cvt_pk_bf16_f32 v201, v26, v27
    v_fma_f32 v30, v15, v29, -v28
    v_mov_b32 v23, v34
    v_fma_f32 v31, v15, v30, -v29
    v_mov_b32 v24, v35
    v_cvt_pk_bf16_f32 v202, v28, v29
    v_cvt_pk_bf16_f32 v203, v30, v31
    v_mul_f32 v25, v23, v13
    v_mul_f32 v34, v23, v21
    v_fma_f32 v25, -v24, v20, v25
    v_mul_f32 v35, v24, v21
    v_fma_f32 v26, v15, v25, -v23
    v_fma_f32 v34, -v24, v22, v34
    v_fma_f32 v27, v15, v26, -v25
    v_fma_f32 v35, v23, v22, v35
    v_fma_f32 v28, v15, v27, -v26
    v_cvt_pk_bf16_f32 v204, v23, v25
    v_fma_f32 v29, v15, v28, -v27
    v_cvt_pk_bf16_f32 v205, v26, v27
    v_fma_f32 v30, v15, v29, -v28
    v_mov_b32 v23, v34
    v_fma_f32 v31, v15, v30, -v29
    v_mov_b32 v24, v35
    v_cvt_pk_bf16_f32 v206, v28, v29
    v_cvt_pk_bf16_f32 v207, v30, v31
    v_mul_f32 v25, v23, v13
    v_mul_f32 v34, v23, v21
    v_fma_f32 v25, -v24, v20, v25
    v_mul_f32 v35, v24, v21
    v_fma_f32 v26, v15, v25, -v23
    v_fma_f32 v34, -v24, v22, v34
    v_fma_f32 v27, v15, v26, -v25
    v_fma_f32 v35, v23, v22, v35
    v_fma_f32 v28, v15, v27, -v26
    v_cvt_pk_bf16_f32 v208, v23, v25
    v_fma_f32 v29, v15, v28, -v27
    v_cvt_pk_bf16_f32 v209, v26, v27
    v_fma_f32 v30, v15, v29, -v28
    v_mov_b32 v23, v34
    v_fma_f32 v31, v15, v30, -v29
    v_mov_b32 v24, v35
    v_cvt_pk_bf16_f32 v210, v28, v29
    v_cvt_pk_bf16_f32 v211, v30, v31
    v_mul_f32 v25, v23, v13
    v_mul_f32 v34, v23, v21
    v_fma_f32 v25, -v24, v20, v25
    v_mul_f32 v35, v24, v21
    v_fma_f32 v26, v15, v25, -v23
    v_fma_f32 v34, -v24, v22, v34
    v_fma_f32 v27, v15, v26, -v25
    v_fma_f32 v35, v23, v22, v35
    v_fma_f32 v28, v15, v27, -v26
    v_cvt_pk_bf16_f32 v212, v23, v25
    v_fma_f32 v29, v15, v28, -v27
    v_cvt_pk_bf16_f32 v213, v26, v27
    v_fma_f32 v30, v15, v29, -v28
    v_mov_b32 v23, v34
    v_fma_f32 v31, v15, v30, -v29
    v_mov_b32 v24, v35
    v_cvt_pk_bf16_f32 v214, v28, v29
    v_cvt_pk_bf16_f32 v215, v30, v31
    v_mul_f32 v25, v23, v13
    v_mul_f32 v34, v23, v21
    v_fma_f32 v25, -v24, v20, v25
    v_mul_f32 v35, v24, v21
    v_fma_f32 v26, v15, v25, -v23
    v_fma_f32 v34, -v24, v22, v34
    v_fma_f32 v27, v15, v26, -v25
    v_fma_f32 v35, v23, v22, v35
    v_fma_f32 v28, v15, v27, -v26
    v_cvt_pk_bf16_f32 v216, v23, v25
    v_fma_f32 v29, v15, v28, -v27
    v_cvt_pk_bf16_f32 v217, v26, v27
    v_fma_f32 v30, v15, v29, -v28
    v_mov_b32 v23, v34
    v_fma_f32 v31, v15, v30, -v29
    v_mov_b32 v24, v35
    v_cvt_pk_bf16_f32 v218, v28, v29
    v_cvt_pk_bf16_f32 v219, v30, v31
    v_mul_f32 v25, v23, v13
    v_mul_f32 v34, v23, v21
    v_fma_f32 v25, -v24, v20, v25
    v_mul_f32 v35, v24, v21
    v_fma_f32 v26, v15, v25, -v23
    v_fma_f32 v34, -v24, v22, v34
    v_fma_f32 v27, v15, v26, -v25
    v_fma_f32 v35, v23, v22, v35
    v_fma_f32 v28, v15, v27, -v26
    v_cvt_pk_bf16_f32 v220, v23, v25
    v_fma_f32 v29, v15, v28, -v27
    v_cvt_pk_bf16_f32 v221, v26, v27
    v_fma_f32 v30, v15, v29, -v28
    v_mov_b32 v23, v34
    v_fma_f32 v31, v15, v30, -v29
    v_mov_b32 v24, v35
    v_cvt_pk_bf16_f32 v222, v28, v29
    v_cvt_pk_bf16_f32 v223, v30, v31
    v_mul_f32 v25, v23, v13
    v_mul_f32 v34, v23, v21
    v_fma_f32 v25, -v24, v20, v25
    v_mul_f32 v35, v24, v21
    v_fma_f32 v26, v15, v25, -v23
    v_fma_f32 v34, -v24, v22, v34
    v_fma_f32 v27, v15, v26, -v25
    v_fma_f32 v35, v23, v22, v35
    v_fma_f32 v28, v15, v27, -v26
    v_cvt_pk_bf16_f32 v224, v23, v25
    v_fma_f32 v29, v15, v28, -v27
    v_cvt_pk_bf16_f32 v225, v26, v27
    v_fma_f32 v30, v15, v29, -v28
    v_mov_b32 v23, v34
    v_fma_f32 v31, v15, v30, -v29
    v_mov_b32 v24, v35
    v_cvt_pk_bf16_f32 v226, v28, v29
    v_cvt_pk_bf16_f32 v227, v30, v31
    v_mul_f32 v25, v23, v13
    v_mul_f32 v34, v23, v21
    v_fma_f32 v25, -v24, v20, v25
    v_mul_f32 v35, v24, v21
    v_fma_f32 v26, v15, v25, -v23
    v_fma_f32 v34, -v24, v22, v34
    v_fma_f32 v27, v15, v26, -v25
    v_fma_f32 v35, v23, v22, v35
    v_fma_f32 v28, v15, v27, -v26
    v_cvt_pk_bf16_f32 v228, v23, v25
    v_fma_f32 v29, v15, v28, -v27
    v_cvt_pk_bf16_f32 v229, v26, v27
    v_fma_f32 v30, v15, v29, -v28
    v_mov_b32 v23, v34
    v_fma_f32 v31, v15, v30, -v29
    v_mov_b32 v24, v35
    v_cvt_pk_bf16_f32 v230, v28, v29
    v_cvt_pk_bf16_f32 v231, v30, v31
    v_mul_f32 v25, v23, v13
    v_mul_f32 v34, v23, v21
    v_fma_f32 v25, -v24, v20, v25
    v_mul_f32 v35, v24, v21
    v_fma_f32 v26, v15, v25, -v23
    v_fma_f32 v34, -v24, v22, v34
    v_fma_f32 v27, v15, v26, -v25
    v_fma_f32 v35, v23, v22, v35
    v_fma_f32 v28, v15, v27, -v26
    v_cvt_pk_bf16_f32 v232, v23, v25
    v_fma_f32 v29, v15, v28, -v27
    v_cvt_pk_bf16_f32 v233, v26, v27
    v_fma_f32 v30, v15, v29, -v28
    v_mov_b32 v23, v34
    v_fma_f32 v31, v15, v30, -v29
    v_mov_b32 v24, v35
    v_cvt_pk_bf16_f32 v234, v28, v29
    v_cvt_pk_bf16_f32 v235, v30, v31
    v_mul_f32 v25, v23, v13
    v_mul_f32 v34, v23, v21
    v_fma_f32 v25, -v24, v20, v25
    v_mul_f32 v35, v24, v21
    v_fma_f32 v26, v15, v25, -v23
    v_fma_f32 v34, -v24, v22, v34
    v_fma_f32 v27, v15, v26, -v25
    v_fma_f32 v35, v23, v22, v35
    v_fma_f32 v28, v15, v27, -v26
    v_cvt_pk_bf16_f32 v236, v23, v25
    v_fma_f32 v29, v15, v28, -v27
    v_cvt_pk_bf16_f32 v237, v26, v27
    v_fma_f32 v30, v15, v29, -v28
    v_mov_b32 v23, v34
    v_fma_f32 v31, v15, v30, -v29
    v_mov_b32 v24, v35
    v_cvt_pk_bf16_f32 v238, v28, v29
    v_cvt_pk_bf16_f32 v239, v30, v31
    v_mul_f32 v25, v23, v13
    v_mul_f32 v34, v23, v21
    v_fma_f32 v25, -v24, v20, v25
    v_mul_f32 v35, v24, v21
    v_fma_f32 v26, v15, v25, -v23
    v_fma_f32 v34, -v24, v22, v34
    v_fma_f32 v27, v15, v26, -v25
    v_fma_f32 v35, v23, v22, v35
    v_fma_f32 v28, v15, v27, -v26
    v_cvt_pk_bf16_f32 v240, v23, v25
    v_fma_f32 v29, v15, v28, -v27
    v_cvt_pk_bf16_f32 v241, v26, v27
    v_fma_f32 v30, v15, v29, -v28
    v_mov_b32 v23, v34
    v_fma_f32 v31, v15, v30, -v29
    v_mov_b32 v24, v35
    v_cvt_pk_bf16_f32 v242, v28, v29
    v_cvt_pk_bf16_f32 v243, v30, v31
    s_branch K0_LN
K0_GEN:
    s_lshl_b32 s34, s2, 1
    s_add_u32 s34, s34, s3
    s_sub_u32 s34, s34, 6
K0_GL:
    s_cmp_ge_u32 s34, 706
    s_cbranch_scc1 K0_DONE
    s_cmp_ge_u32 s34, 666
    s_cbranch_scc1 K0_GC
    s_mul_i32 s35, s34, 1772
    s_lshr_b32 s35, s35, 16
    s_mul_i32 s36, s35, 37
    s_sub_u32 s36, s34, s36
    v_and_b32 v6, 0x13, v3
    v_bfe_u32 v7, v3, 2, 1
    v_lshl_or_b32 v6, v7, 3, v6
    v_bfe_u32 v7, v3, 3, 1
    v_lshl_or_b32 v6, v7, 2, v6
    s_lshl_b32 s37, s35, 5
    v_add_u32 v6, s37, v6
    v_cvt_f32_u32 v9, v6
    s_lshl_b32 s37, s36, 3
    v_lshlrev_b32 v7, 2, v4
    v_add_u32 v7, s37, v7
    v_add_u32 v8, 0, v7
    v_cvt_f32_u32 v12, v8
    v_mul_f32 v16, v12, v9
    v_cmp_eq_u32 s[40:41], 0, v8
    v_mov_b32 v17, 288
    v_cmp_eq_u32 s[42:43], v17, v8
    v_cmp_lt_u32 s[44:45], v17, v8
    s_or_b64 s[40:41], s[40:41], s[42:43]
    v_mov_b32 v17, 0x35e38e39
    v_mov_b32 v18, 0x35638e39
    v_cndmask_b32 v17, v17, v18, s[40:41]
    v_cndmask_b32 v17, v17, 0, s[44:45]
    v_mov_b32 v10, 0
    v_mul_f32 v14, s30, v16
    v_rndne_f32 v14, v14
    v_fma_f32 v14, s31, v14, v16
    v_fma_f32 v14, s30, v14, v10
    v_cos_f32 v20, v14
    s_nop 0
    v_mul_f32 v20, v20, v17
    v_cndmask_b32 v17, v17, 0, s[40:41]
    v_mov_b32 v10, 0.25
    v_mul_f32 v14, s30, v16
    v_rndne_f32 v14, v14
    v_fma_f32 v14, s31, v14, v16
    v_fma_f32 v14, s30, v14, v10
    v_cos_f32 v21, v14
    s_nop 0
    v_mul_f32 v21, v21, v17
    v_add_u32 v8, 1, v7
    v_cvt_f32_u32 v12, v8
    v_mul_f32 v16, v12, v9
    v_cmp_eq_u32 s[40:41], 0, v8
    v_mov_b32 v17, 288
    v_cmp_eq_u32 s[42:43], v17, v8
    v_cmp_lt_u32 s[44:45], v17, v8
    s_or_b64 s[40:41], s[40:41], s[42:43]
    v_mov_b32 v17, 0x35e38e39
    v_mov_b32 v18, 0x35638e39
    v_cndmask_b32 v17, v17, v18, s[40:41]
    v_cndmask_b32 v17, v17, 0, s[44:45]
    v_mov_b32 v10, 0
    v_mul_f32 v14, s30, v16
    v_rndne_f32 v14, v14
    v_fma_f32 v14, s31, v14, v16
    v_fma_f32 v14, s30, v14, v10
    v_cos_f32 v22, v14
    s_nop 0
    v_mul_f32 v22, v22, v17
    v_cndmask_b32 v17, v17, 0, s[40:41]
    v_mov_b32 v10, 0.25
    v_mul_f32 v14, s30, v16
    v_rndne_f32 v14, v14
    v_fma_f32 v14, s31, v14, v16
    v_fma_f32 v14, s30, v14, v10
    v_cos_f32 v23, v14
    s_nop 0
    v_mul_f32 v23, v23, v17
    v_add_u32 v8, 2, v7
    v_cvt_f32_u32 v12, v8
    v_mul_f32 v16, v12, v9
    v_cmp_eq_u32 s[40:41], 0, v8
    v_mov_b32 v17, 288
    v_cmp_eq_u32 s[42:43], v17, v8
    v_cmp_lt_u32 s[44:45], v17, v8
    s_or_b64 s[40:41], s[40:41], s[42:43]
    v_mov_b32 v17, 0x35e38e39
    v_mov_b32 v18, 0x35638e39
    v_cndmask_b32 v17, v17, v18, s[40:41]
    v_cndmask_b32 v17, v17, 0, s[44:45]
    v_mov_b32 v10, 0
    v_mul_f32 v14, s30, v16
    v_rndne_f32 v14, v14
    v_fma_f32 v14, s31, v14, v16
    v_fma_f32 v14, s30, v14, v10
    v_cos_f32 v24, v14
    s_nop 0
    v_mul_f32 v24, v24, v17
    v_cndmask_b32 v17, v17, 0, s[40:41]
    v_mov_b32 v10, 0.25
    v_mul_f32 v14, s30, v16
    v_rndne_f32 v14, v14
    v_fma_f32 v14, s31, v14, v16
    v_fma_f32 v14, s30, v14, v10
    v_cos_f32 v25, v14
    s_nop 0
    v_mul_f32 v25, v25, v17
    v_add_u32 v8, 3, v7
    v_cvt_f32_u32 v12, v8
    v_mul_f32 v16, v12, v9
    v_cmp_eq_u32 s[40:41], 0, v8
    v_mov_b32 v17, 288
    v_cmp_eq_u32 s[42:43], v17, v8
    v_cmp_lt_u32 s[44:45], v17, v8
    s_or_b64 s[40:41], s[40:41], s[42:43]
    v_mov_b32 v17, 0x35e38e39
    v_mov_b32 v18, 0x35638e39
    v_cndmask_b32 v17, v17, v18, s[40:41]
    v_cndmask_b32 v17, v17, 0, s[44:45]
    v_mov_b32 v10, 0
    v_mul_f32 v14, s30, v16
    v_rndne_f32 v14, v14
    v_fma_f32 v14, s31, v14, v16
    v_fma_f32 v14, s30, v14, v10
    v_cos_f32 v26, v14
    s_nop 0
    v_mul_f32 v26, v26, v17
    v_cndmask_b32 v17, v17, 0, s[40:41]
    v_mov_b32 v10, 0.25
    v_mul_f32 v14, s30, v16
    v_rndne_f32 v14, v14
    v_fma_f32 v14, s31, v14, v16
    v_fma_f32 v14, s30, v14, v10
    v_cos_f32 v27, v14
    s_nop 0
    v_mul_f32 v27, v27, v17
    v_cvt_pk_bf16_f32 v28, v20, v21
    v_cvt_pk_bf16_f32 v29, v22, v23
    v_cvt_pk_bf16_f32 v30, v24, v25
    v_cvt_pk_bf16_f32 v31, v26, v27
    s_lshl_b32 s37, s34, 10
    s_add_u32 s37, s37, 9961472
    v_lshlrev_b32 v18, 4, v2
    buffer_store_dwordx4 v[28:31], v18, s[8:11], s37 offen sc1
    s_branch K0_GN
K0_GC:
    s_sub_u32 s35, s34, 666
    s_cmp_ge_u32 s35, 24
    s_cbranch_scc1 K0_GTW
    s_cmp_ge_u32 s35, 8
    s_cbranch_scc1 K0_G64
    s_and_b32 s36, s35, 3
    s_lshr_b32 s37, s35, 2
    s_lshl_b32 s36, s36, 3
    v_lshlrev_b32 v7, 2, v4
    v_add_u32 v7, s36, v7
    v_cvt_f32_u32 v9, v3
    s_mov_b32 s40, 0x3d000000
    s_mov_b32 s41, 0xc2000000
    s_cmp_eq_u32 s37, 0
    s_cselect_b32 s42, 0, 0x3e800000
    s_cselect_b32 s43, 0xbe800000, 0
    v_add_u32 v8, 0, v7
    v_cvt_f32_u32 v12, v8
    v_mul_f32 v16, v12, v9
    v_mov_b32 v10, s42
    v_mul_f32 v14, s40, v16
    v_rndne_f32 v14, v14
    v_fma_f32 v14, s41, v14, v16
    v_fma_f32 v14, s40, v14, v10
    v_cos_f32 v20, v14
    v_add_u32 v8, 0, v7
    v_cvt_f32_u32 v12, v8
    v_mul_f32 v16, v12, v9
    v_mov_b32 v10, s43
    v_mul_f32 v14, s40, v16
    v_rndne_f32 v14, v14
    v_fma_f32 v14, s41, v14, v16
    v_fma_f32 v14, s40, v14, v10
    v_cos_f32 v21, v14
    v_add_u32 v8, 1, v7
    v_cvt_f32_u32 v12, v8
    v_mul_f32 v16, v12, v9
    v_mov_b32 v10, s42
    v_mul_f32 v14, s40, v16
    v_rndne_f32 v14, v14
    v_fma_f32 v14, s41, v14, v16
    v_fma_f32 v14, s40, v14, v10
    v_cos_f32 v22, v14
    v_add_u32 v8, 1, v7
    v_cvt_f32_u32 v12, v8
    v_mul_f32 v16, v12, v9
    v_mov_b32 v10, s43
    v_mul_f32 v14, s40, v16
    v_rndne_f32 v14, v14
    v_fma_f32 v14, s41, v14, v16
    v_fma_f32 v14, s40, v14, v10
    v_cos_f32 v23, v14
    v_add_u32 v8, 2, v7
    v_cvt_f32_u32 v12, v8
    v_mul_f32 v16, v12, v9
    v_mov_b32 v10, s42
    v_mul_f32 v14, s40, v16
    v_rndne_f32 v14, v14
    v_fma_f32 v14, s41, v14, v16
    v_fma_f32 v14, s40, v14, v10
    v_cos_f32 v24, v14
    v_add_u32 v8, 2, v7
    v_cvt_f32_u32 v12, v8
    v_mul_f32 v16, v12, v9
    v_mov_b32 v10, s43
    v_mul_f32 v14, s40, v16
    v_rndne_f32 v14, v14
    v_fma_f32 v14, s41, v14, v16
    v_fma_f32 v14, s40, v14, v10
    v_cos_f32 v25, v14
    v_add_u32 v8, 3, v7
    v_cvt_f32_u32 v12, v8
    v_mul_f32 v16, v12, v9
    v_mov_b32 v10, s42
    v_mul_f32 v14, s40, v16
    v_rndne_f32 v14, v14
    v_fma_f32 v14, s41, v14, v16
    v_fma_f32 v14, s40, v14, v10
    v_cos_f32 v26, v14
    v_add_u32 v8, 3, v7
    v_cvt_f32_u32 v12, v8
    v_mul_f32 v16, v12, v9
    v_mov_b32 v10, s43
    v_mul_f32 v14, s40, v16
    v_rndne_f32 v14, v14
    v_fma_f32 v14, s41, v14, v16
    v_fma_f32 v14, s40, v14, v10
    v_cos_f32 v27, v14
    s_nop 0
    v_cvt_pk_bf16_f32 v28, v20, v21
    v_cvt_pk_bf16_f32 v29, v22, v23
    v_cvt_pk_bf16_f32 v30, v24, v25
    v_cvt_pk_bf16_f32 v31, v26, v27
    s_lshl_b32 s37, s35, 10
    s_add_u32 s37, s37, 10682368
    v_lshlrev_b32 v18, 4, v2
    buffer_store_dwordx4 v[28:31], v18, s[8:11], s37 offen sc1
    s_branch K0_GN
K0_G64:
    s_sub_u32 s35, s35, 8
    s_and_b32 s36, s35, 3
    s_lshl_b32 s36, s36, 4
    s_lshr_b32 s37, s35, 3
    s_lshl_b32 s37, s37, 5
    v_add_u32 v9, s37, v3
    v_cvt_f32_u32 v9, v9
    v_lshlrev_b32 v7, 2, v4
    v_add_u32 v7, s36, v7
    s_mov_b32 s40, 0x3c800000
    s_mov_b32 s41, 0xc2800000
    s_bitcmp1_b32 s35, 2
    s_cselect_b32 s42, 0x3e800000, 0
    v_mov_b32 v10, s42
    v_add_u32 v8, 0, v7
    v_cvt_f32_u32 v12, v8
    v_mul_f32 v16, v12, v9
    v_mul_f32 v14, s40, v16
    v_rndne_f32 v14, v14
    v_fma_f32 v14, s41, v14, v16
    v_fma_f32 v14, s40, v14, v10
    v_cos_f32 v20, v14
    v_add_u32 v8, 1, v7
    v_cvt_f32_u32 v12, v8
    v_mul_f32 v16, v12, v9
    v_mul_f32 v14, s40, v16
    v_rndne_f32 v14, v14
    v_fma_f32 v14, s41, v14, v16
    v_fma_f32 v14, s40, v14, v10
    v_cos_f32 v21, v14
    v_add_u32 v8, 2, v7
    v_cvt_f32_u32 v12, v8
    v_mul_f32 v16, v12, v9
    v_mul_f32 v14, s40, v16
    v_rndne_f32 v14, v14
    v_fma_f32 v14, s41, v14, v16
    v_fma_f32 v14, s40, v14, v10
    v_cos_f32 v22, v14
    v_add_u32 v8, 3, v7
    v_cvt_f32_u32 v12, v8
    v_mul_f32 v16, v12, v9
    v_mul_f32 v14, s40, v16
    v_rndne_f32 v14, v14
    v_fma_f32 v14, s41, v14, v16
    v_fma_f32 v14, s40, v14, v10
    v_cos_f32 v23, v14
    v_add_u32 v8, 8, v7
    v_cvt_f32_u32 v12, v8
    v_mul_f32 v16, v12, v9
    v_mul_f32 v14, s40, v16
    v_rndne_f32 v14, v14
    v_fma_f32 v14, s41, v14, v16
    v_fma_f32 v14, s40, v14, v10
    v_cos_f32 v24, v14
    v_add_u32 v8, 9, v7
    v_cvt_f32_u32 v12, v8
    v_mul_f32 v16, v12, v9
    v_mul_f32 v14, s40, v16
    v_rndne_f32 v14, v14
    v_fma_f32 v14, s41, v14, v16
    v_fma_f32 v14, s40, v14, v10
    v_cos_f32 v25, v14
    v_add_u32 v8, 10, v7
    v_cvt_f32_u32 v12, v8
    v_mul_f32 v16, v12, v9
    v_mul_f32 v14, s40, v16
    v_rndne_f32 v14, v14
    v_fma_f32 v14, s41, v14, v16
    v_fma_f32 v14, s40, v14, v10
    v_cos_f32 v26, v14
    v_add_u32 v8, 11, v7
    v_cvt_f32_u32 v12, v8
    v_mul_f32 v16, v12, v9
    v_mul_f32 v14, s40, v16
    v_rndne_f32 v14, v14
    v_fma_f32 v14, s41, v14, v16
    v_fma_f32 v14, s40, v14, v10
    v_cos_f32 v27, v14
    s_nop 0
    v_cvt_pk_bf16_f32 v28, v20, v21
    v_cvt_pk_bf16_f32 v29, v22, v23
    v_cvt_pk_bf16_f32 v30, v24, v25
    v_cvt_pk_bf16_f32 v31, v26, v27
    s_lshl_b32 s37, s35, 10
    s_add_u32 s37, s37, 10690560
    v_lshlrev_b32 v18, 4, v2
    buffer_store_dwordx4 v[28:31], v18, s[8:11], s37 offen sc1
    s_branch K0_GN
K0_GTW:
    s_sub_u32 s35, s35, 24
    s_lshr_b32 s36, s35, 1
    s_lshl_b32 s36, s36, 3
    v_lshlrev_b32 v7, 2, v4
    v_add_u32 v7, s36, v7
    v_cvt_f32_u32 v9, v3
    s_mov_b32 s40, 0x3a000000
    s_mov_b32 s41, 0xc5000000
    s_bitcmp1_b32 s35, 0
    s_cselect_b32 s42, 0x3e800000, 0
    v_mov_b32 v10, s42
    v_add_u32 v8, 0, v7
    v_cvt_f32_u32 v12, v8
    v_mul_f32 v16, v12, v9
    v_mul_f32 v14, s40, v16
    v_rndne_f32 v14, v14
    v_fma_f32 v14, s41, v14, v16
    v_fma_f32 v14, s40, v14, v10
    v_cos_f32 v20, v14
    v_add_u32 v8, 1, v7
    v_cvt_f32_u32 v12, v8
    v_mul_f32 v16, v12, v9
    v_mul_f32 v14, s40, v16
    v_rndne_f32 v14, v14
    v_fma_f32 v14, s41, v14, v16
    v_fma_f32 v14, s40, v14, v10
    v_cos_f32 v21, v14
    v_add_u32 v8, 2, v7
    v_cvt_f32_u32 v12, v8
    v_mul_f32 v16, v12, v9
    v_mul_f32 v14, s40, v16
    v_rndne_f32 v14, v14
    v_fma_f32 v14, s41, v14, v16
    v_fma_f32 v14, s40, v14, v10
    v_cos_f32 v22, v14
    v_add_u32 v8, 3, v7
    v_cvt_f32_u32 v12, v8
    v_mul_f32 v16, v12, v9
    v_mul_f32 v14, s40, v16
    v_rndne_f32 v14, v14
    v_fma_f32 v14, s41, v14, v16
    v_fma_f32 v14, s40, v14, v10
    v_cos_f32 v23, v14
    s_lshl_b32 s37, s35, 10
    s_add_u32 s37, s37, 10706944
    v_lshlrev_b32 v18, 4, v2
    s_nop 0
    buffer_store_dwordx4 v[20:23], v18, s[8:11], s37 offen sc1
K0_GN:
    s_add_u32 s34, s34, 448
    s_nop 1
    s_branch K0_GL
K0_LN:
    s_lshl_b32 s36, s26, 5
    v_add_u32 v5, s36, v3
    v_mul_u32_u24 v5, 1168, v5
    v_lshl_add_u32 v5, v4, 4, v5
    v_add_u32 v5, s33, v5
    s_waitcnt vmcnt(0)
    s_barrier
    ds_read_b128 v[64:67], v5 offset:0
    ds_read_b128 v[68:71], v5 offset:32
    ds_read_b128 v[72:75], v5 offset:64
    ds_read_b128 v[76:79], v5 offset:96
    ds_read_b128 v[80:83], v5 offset:128
    ds_read_b128 v[84:87], v5 offset:160
    ds_read_b128 v[88:91], v5 offset:192
    ds_read_b128 v[92:95], v5 offset:224
    ds_read_b128 v[96:99], v5 offset:256
    s_waitcnt lgkmcnt(0)
    v_lshlrev_b32 v100, 16, v64
    v_and_b32 v101, 0xffff0000, v64
    v_lshlrev_b32 v102, 16, v65
    v_and_b32 v103, 0xffff0000, v65
    v_lshlrev_b32 v104, 16, v66
    v_and_b32 v105, 0xffff0000, v66
    v_lshlrev_b32 v106, 16, v67
    v_and_b32 v107, 0xffff0000, v67
    v_lshlrev_b32 v108, 16, v68
    v_and_b32 v109, 0xffff0000, v68
    v_lshlrev_b32 v110, 16, v69
    v_and_b32 v111, 0xffff0000, v69
    v_lshlrev_b32 v112, 16, v70
    v_and_b32 v113, 0xffff0000, v70
    v_lshlrev_b32 v114, 16, v71
    v_and_b32 v115, 0xffff0000, v71
    v_lshlrev_b32 v116, 16, v72
    v_and_b32 v117, 0xffff0000, v72
    v_lshlrev_b32 v118, 16, v73
    v_and_b32 v119, 0xffff0000, v73
    v_lshlrev_b32 v120, 16, v74
    v_and_b32 v121, 0xffff0000, v74
    v_lshlrev_b32 v122, 16, v75
    v_and_b32 v123, 0xffff0000, v75
    v_lshlrev_b32 v124, 16, v76
    v_and_b32 v125, 0xffff0000, v76
    v_lshlrev_b32 v126, 16, v77
    v_and_b32 v127, 0xffff0000, v77
    v_lshlrev_b32 v128, 16, v78
    v_and_b32 v129, 0xffff0000, v78
    v_lshlrev_b32 v130, 16, v79
    v_and_b32 v131, 0xffff0000, v79
    v_lshlrev_b32 v132, 16, v80
    v_and_b32 v133, 0xffff0000, v80
    v_lshlrev_b32 v134, 16, v81
    v_and_b32 v135, 0xffff0000, v81
    v_lshlrev_b32 v136, 16, v82
    v_and_b32 v137, 0xffff0000, v82
    v_lshlrev_b32 v138, 16, v83
    v_and_b32 v139, 0xffff0000, v83
    v_lshlrev_b32 v140, 16, v84
    v_and_b32 v141, 0xffff0000, v84
    v_lshlrev_b32 v142, 16, v85
    v_and_b32 v143, 0xffff0000, v85
    v_lshlrev_b32 v144, 16, v86
    v_and_b32 v145, 0xffff0000, v86
    v_lshlrev_b32 v146, 16, v87
    v_and_b32 v147, 0xffff0000, v87
    v_lshlrev_b32 v148, 16, v88
    v_and_b32 v149, 0xffff0000, v88
    v_lshlrev_b32 v150, 16, v89
    v_and_b32 v151, 0xffff0000, v89
    v_lshlrev_b32 v152, 16, v90
    v_and_b32 v153, 0xffff0000, v90
    v_lshlrev_b32 v154, 16, v91
    v_and_b32 v155, 0xffff0000, v91
    v_lshlrev_b32 v156, 16, v92
    v_and_b32 v157, 0xffff0000, v92
    v_lshlrev_b32 v158, 16, v93
    v_and_b32 v159, 0xffff0000, v93
    v_lshlrev_b32 v160, 16, v94
    v_and_b32 v161, 0xffff0000, v94
    v_lshlrev_b32 v162, 16, v95
    v_and_b32 v163, 0xffff0000, v95
    v_lshlrev_b32 v164, 16, v96
    v_and_b32 v165, 0xffff0000, v96
    v_lshlrev_b32 v166, 16, v97
    v_and_b32 v167, 0xffff0000, v97
    v_lshlrev_b32 v168, 16, v98
    v_and_b32 v169, 0xffff0000, v98
    v_lshlrev_b32 v170, 16, v99
    v_and_b32 v171, 0xffff0000, v99
    v_mov_b32 v20, v100
    v_mov_b32 v21, v101
    v_mov_b32 v22, v102
    v_mov_b32 v23, v103
    v_mov_b32 v24, v104
    v_mov_b32 v25, v105
    v_mov_b32 v26, v106
    v_mov_b32 v27, v107
    v_pk_add_f32 v[20:21], v[108:109], v[20:21]
    v_pk_add_f32 v[22:23], v[110:111], v[22:23]
    v_pk_add_f32 v[24:25], v[112:113], v[24:25]
    v_pk_add_f32 v[26:27], v[114:115], v[26:27]
    v_pk_add_f32 v[20:21], v[116:117], v[20:21]
    v_pk_add_f32 v[22:23], v[118:119], v[22:23]
    v_pk_add_f32 v[24:25], v[120:121], v[24:25]
    v_pk_add_f32 v[26:27], v[122:123], v[26:27]
    v_pk_add_f32 v[20:21], v[124:125], v[20:21]
    v_pk_add_f32 v[22:23], v[126:127], v[22:23]
    v_pk_add_f32 v[24:25], v[128:129], v[24:25]
    v_pk_add_f32 v[26:27], v[130:131], v[26:27]
    v_pk_add_f32 v[20:21], v[132:133], v[20:21]
    v_pk_add_f32 v[22:23], v[134:135], v[22:23]
    v_pk_add_f32 v[24:25], v[136:137], v[24:25]
    v_pk_add_f32 v[26:27], v[138:139], v[26:27]
    v_pk_add_f32 v[20:21], v[140:141], v[20:21]
    v_pk_add_f32 v[22:23], v[142:143], v[22:23]
    v_pk_add_f32 v[24:25], v[144:145], v[24:25]
    v_pk_add_f32 v[26:27], v[146:147], v[26:27]
    v_pk_add_f32 v[20:21], v[148:149], v[20:21]
    v_pk_add_f32 v[22:23], v[150:151], v[22:23]
    v_pk_add_f32 v[24:25], v[152:153], v[24:25]
    v_pk_add_f32 v[26:27], v[154:155], v[26:27]
    v_pk_add_f32 v[20:21], v[156:157], v[20:21]
    v_pk_add_f32 v[22:23], v[158:159], v[22:23]
    v_pk_add_f32 v[24:25], v[160:161], v[24:25]
    v_pk_add_f32 v[26:27], v[162:163], v[26:27]
    v_pk_add_f32 v[20:21], v[164:165], v[20:21]
    v_pk_add_f32 v[22:23], v[166:167], v[22:23]
    v_pk_add_f32 v[24:25], v[168:169], v[24:25]
    v_pk_add_f32 v[26:27], v[170:171], v[26:27]
    v_pk_add_f32 v[20:21], v[20:21], v[22:23]
    v_pk_add_f32 v[24:25], v[24:25], v[26:27]
    v_pk_add_f32 v[20:21], v[20:21], v[24:25]
    s_nop 0
    v_add_f32 v6, v20, v21
    s_lshl_b32 s36, s26, 10
    s_lshl_b32 s37, s27, 3
    s_add_u32 s37, s37, s36
    s_add_u32 s37, s37, 75776
    v_lshlrev_b32 v7, 5, v3
    v_lshl_add_u32 v8, v4, 2, v7
    v_add_u32 v8, s37, v8
    s_add_u32 s36, s36, 75776
    v_add_u32 v7, s36, v7
    ds_write_b32 v8, v6
    s_waitcnt lgkmcnt(0)
    s_barrier
    ds_read_b128 v[20:23], v7
    ds_read_b128 v[24:27], v7 offset:16
    s_waitcnt lgkmcnt(0)
    v_pk_add_f32 v[20:21], v[20:21], v[22:23]
    v_pk_add_f32 v[24:25], v[24:25], v[26:27]
    v_pk_add_f32 v[20:21], v[20:21], v[24:25]
    s_nop 0
    v_add_f32 v20, v20, v21
    v_mul_f32 v28, 0xbae38e39, v20
    v_mul_f32 v29, 0xbae38e39, v20
    v_pk_add_f32 v[100:101], v[100:101], v[28:29]
    v_pk_add_f32 v[102:103], v[102:103], v[28:29]
    v_pk_add_f32 v[104:105], v[104:105], v[28:29]
    v_pk_add_f32 v[106:107], v[106:107], v[28:29]
    v_pk_add_f32 v[108:109], v[108:109], v[28:29]
    v_pk_add_f32 v[110:111], v[110:111], v[28:29]
    v_pk_add_f32 v[112:113], v[112:113], v[28:29]
    v_pk_add_f32 v[114:115], v[114:115], v[28:29]
    v_pk_add_f32 v[116:117], v[116:117], v[28:29]
    v_pk_add_f32 v[118:119], v[118:119], v[28:29]
    v_pk_add_f32 v[120:121], v[120:121], v[28:29]
    v_pk_add_f32 v[122:123], v[122:123], v[28:29]
    v_pk_add_f32 v[124:125], v[124:125], v[28:29]
    v_pk_add_f32 v[126:127], v[126:127], v[28:29]
    v_pk_add_f32 v[128:129], v[128:129], v[28:29]
    v_pk_add_f32 v[130:131], v[130:131], v[28:29]
    v_pk_add_f32 v[132:133], v[132:133], v[28:29]
    v_pk_add_f32 v[134:135], v[134:135], v[28:29]
    v_pk_add_f32 v[136:137], v[136:137], v[28:29]
    v_pk_add_f32 v[138:139], v[138:139], v[28:29]
    v_pk_add_f32 v[140:141], v[140:141], v[28:29]
    v_pk_add_f32 v[142:143], v[142:143], v[28:29]
    v_pk_add_f32 v[144:145], v[144:145], v[28:29]
    v_pk_add_f32 v[146:147], v[146:147], v[28:29]
    v_pk_add_f32 v[148:149], v[148:149], v[28:29]
    v_pk_add_f32 v[150:151], v[150:151], v[28:29]
    v_pk_add_f32 v[152:153], v[152:153], v[28:29]
    v_pk_add_f32 v[154:155], v[154:155], v[28:29]
    v_pk_add_f32 v[156:157], v[156:157], v[28:29]
    v_pk_add_f32 v[158:159], v[158:159], v[28:29]
    v_pk_add_f32 v[160:161], v[160:161], v[28:29]
    v_pk_add_f32 v[162:163], v[162:163], v[28:29]
    v_pk_add_f32 v[164:165], v[164:165], v[28:29]
    v_pk_add_f32 v[166:167], v[166:167], v[28:29]
    v_pk_add_f32 v[168:169], v[168:169], v[28:29]
    v_pk_add_f32 v[170:171], v[170:171], v[28:29]
    v_pk_mul_f32 v[20:21], v[100:101], v[100:101]
    v_pk_mul_f32 v[22:23], v[102:103], v[102:103]
    v_pk_mul_f32 v[24:25], v[104:105], v[104:105]
    v_pk_mul_f32 v[26:27], v[106:107], v[106:107]
    v_pk_fma_f32 v[20:21], v[108:109], v[108:109], v[20:21]
    v_pk_fma_f32 v[22:23], v[110:111], v[110:111], v[22:23]
    v_pk_fma_f32 v[24:25], v[112:113], v[112:113], v[24:25]
    v_pk_fma_f32 v[26:27], v[114:115], v[114:115], v[26:27]
    v_pk_fma_f32 v[20:21], v[116:117], v[116:117], v[20:21]
    v_pk_fma_f32 v[22:23], v[118:119], v[118:119], v[22:23]
    v_pk_fma_f32 v[24:25], v[120:121], v[120:121], v[24:25]
    v_pk_fma_f32 v[26:27], v[122:123], v[122:123], v[26:27]
    v_pk_fma_f32 v[20:21], v[124:125], v[124:125], v[20:21]
    v_pk_fma_f32 v[22:23], v[126:127], v[126:127], v[22:23]
    v_pk_fma_f32 v[24:25], v[128:129], v[128:129], v[24:25]
    v_pk_fma_f32 v[26:27], v[130:131], v[130:131], v[26:27]
    v_pk_fma_f32 v[20:21], v[132:133], v[132:133], v[20:21]
    v_pk_fma_f32 v[22:23], v[134:135], v[134:135], v[22:23]
    v_pk_fma_f32 v[24:25], v[136:137], v[136:137], v[24:25]
    v_pk_fma_f32 v[26:27], v[138:139], v[138:139], v[26:27]
    v_pk_fma_f32 v[20:21], v[140:141], v[140:141], v[20:21]
    v_pk_fma_f32 v[22:23], v[142:143], v[142:143], v[22:23]
    v_pk_fma_f32 v[24:25], v[144:145], v[144:145], v[24:25]
    v_pk_fma_f32 v[26:27], v[146:147], v[146:147], v[26:27]
    v_pk_fma_f32 v[20:21], v[148:149], v[148:149], v[20:21]
    v_pk_fma_f32 v[22:23], v[150:151], v[150:151], v[22:23]
    v_pk_fma_f32 v[24:25], v[152:153], v[152:153], v[24:25]
    v_pk_fma_f32 v[26:27], v[154:155], v[154:155], v[26:27]
    v_pk_fma_f32 v[20:21], v[156:157], v[156:157], v[20:21]
    v_pk_fma_f32 v[22:23], v[158:159], v[158:159], v[22:23]
    v_pk_fma_f32 v[24:25], v[160:161], v[160:161], v[24:25]
    v_pk_fma_f32 v[26:27], v[162:163], v[162:163], v[26:27]
    v_pk_fma_f32 v[20:21], v[164:165], v[164:165], v[20:21]
    v_pk_fma_f32 v[22:23], v[166:167], v[166:167], v[22:23]
    v_pk_fma_f32 v[24:25], v[168:169], v[168:169], v[24:25]
    v_pk_fma_f32 v[26:27], v[170:171], v[170:171], v[26:27]
    v_pk_add_f32 v[20:21], v[20:21], v[22:23]
    v_pk_add_f32 v[24:25], v[24:25], v[26:27]
    v_pk_add_f32 v[20:21], v[20:21], v[24:25]
    s_nop 0
    v_add_f32 v6, v20, v21
    ds_write_b32 v8, v6 offset:2048
    s_waitcnt lgkmcnt(0)
    s_barrier
    ds_read_b128 v[20:23], v7 offset:2048
    ds_read_b128 v[24:27], v7 offset:2064
    s_waitcnt lgkmcnt(0)
    v_pk_add_f32 v[20:21], v[20:21], v[22:23]
    v_pk_add_f32 v[24:25], v[24:25], v[26:27]
    v_pk_add_f32 v[20:21], v[20:21], v[24:25]
    s_nop 0
    v_add_f32 v20, v20, v21
    v_mov_b32 v21, 0x3727c5ac
    v_fmac_f32 v21, 0x3ae38e39, v20
    v_rsq_f32 v28, v21
    s_nop 0
    v_mov_b32 v29, v28
    s_mul_i32 s36, s26, 36
    s_mul_i32 s37, s27, 9
    s_add_u32 s36, s36, s37
    s_lshl_b32 s36, s36, 10
    v_lshlrev_b32 v18, 4, v2
    v_add_u32 v17, s36, v18
    v_pk_mul_f32 v[100:101], v[100:101], v[28:29]
    v_pk_mul_f32 v[102:103], v[102:103], v[28:29]
    v_pk_mul_f32 v[104:105], v[104:105], v[28:29]
    v_pk_mul_f32 v[106:107], v[106:107], v[28:29]
    v_pk_mul_f32 v[108:109], v[108:109], v[28:29]
    v_pk_mul_f32 v[110:111], v[110:111], v[28:29]
    v_pk_mul_f32 v[112:113], v[112:113], v[28:29]
    v_pk_mul_f32 v[114:115], v[114:115], v[28:29]
    v_pk_mul_f32 v[116:117], v[116:117], v[28:29]
    v_pk_mul_f32 v[118:119], v[118:119], v[28:29]
    v_pk_mul_f32 v[120:121], v[120:121], v[28:29]
    v_pk_mul_f32 v[122:123], v[122:123], v[28:29]
    v_pk_mul_f32 v[124:125], v[124:125], v[28:29]
    v_pk_mul_f32 v[126:127], v[126:127], v[28:29]
    v_pk_mul_f32 v[128:129], v[128:129], v[28:29]
    v_pk_mul_f32 v[130:131], v[130:131], v[28:29]
    v_pk_mul_f32 v[132:133], v[132:133], v[28:29]
    v_pk_mul_f32 v[134:135], v[134:135], v[28:29]
    v_pk_mul_f32 v[136:137], v[136:137], v[28:29]
    v_pk_mul_f32 v[138:139], v[138:139], v[28:29]
    v_pk_mul_f32 v[140:141], v[140:141], v[28:29]
    v_pk_mul_f32 v[142:143], v[142:143], v[28:29]
    v_pk_mul_f32 v[144:145], v[144:145], v[28:29]
    v_pk_mul_f32 v[146:147], v[146:147], v[28:29]
    v_pk_mul_f32 v[148:149], v[148:149], v[28:29]
    v_pk_mul_f32 v[150:151], v[150:151], v[28:29]
    v_pk_mul_f32 v[152:153], v[152:153], v[28:29]
    v_pk_mul_f32 v[154:155], v[154:155], v[28:29]
    v_pk_mul_f32 v[156:157], v[156:157], v[28:29]
    v_pk_mul_f32 v[158:159], v[158:159], v[28:29]
    v_pk_mul_f32 v[160:161], v[160:161], v[28:29]
    v_pk_mul_f32 v[162:163], v[162:163], v[28:29]
    v_pk_mul_f32 v[164:165], v[164:165], v[28:29]
    v_pk_mul_f32 v[166:167], v[166:167], v[28:29]
    v_pk_mul_f32 v[168:169], v[168:169], v[28:29]
    v_pk_mul_f32 v[170:171], v[170:171], v[28:29]
    v_cvt_pk_bf16_f32 v64, v100, v101
    v_cvt_pk_bf16_f32 v65, v102, v103
    v_cvt_pk_bf16_f32 v66, v104, v105
    v_cvt_pk_bf16_f32 v67, v106, v107
    ds_write_b128 v17, v[64:67] offset:0
    v_cvt_pk_bf16_f32 v68, v108, v109
    v_cvt_pk_bf16_f32 v69, v110, v111
    v_cvt_pk_bf16_f32 v70, v112, v113
    v_cvt_pk_bf16_f32 v71, v114, v115
    ds_write_b128 v17, v[68:71] offset:1024
    v_cvt_pk_bf16_f32 v72, v116, v117
    v_cvt_pk_bf16_f32 v73, v118, v119
    v_cvt_pk_bf16_f32 v74, v120, v121
    v_cvt_pk_bf16_f32 v75, v122, v123
    ds_write_b128 v17, v[72:75] offset:2048
    v_cvt_pk_bf16_f32 v76, v124, v125
    v_cvt_pk_bf16_f32 v77, v126, v127
    v_cvt_pk_bf16_f32 v78, v128, v129
    v_cvt_pk_bf16_f32 v79, v130, v131
    ds_write_b128 v17, v[76:79] offset:3072
    v_cvt_pk_bf16_f32 v80, v132, v133
    v_cvt_pk_bf16_f32 v81, v134, v135
    v_cvt_pk_bf16_f32 v82, v136, v137
    v_cvt_pk_bf16_f32 v83, v138, v139
    ds_write_b128 v17, v[80:83] offset:4096
    v_cvt_pk_bf16_f32 v84, v140, v141
    v_cvt_pk_bf16_f32 v85, v142, v143
    v_cvt_pk_bf16_f32 v86, v144, v145
    v_cvt_pk_bf16_f32 v87, v146, v147
    ds_write_b128 v17, v[84:87] offset:5120
    v_cvt_pk_bf16_f32 v88, v148, v149
    v_cvt_pk_bf16_f32 v89, v150, v151
    v_cvt_pk_bf16_f32 v90, v152, v153
    v_cvt_pk_bf16_f32 v91, v154, v155
    ds_write_b128 v17, v[88:91] offset:6144
    v_cvt_pk_bf16_f32 v92, v156, v157
    v_cvt_pk_bf16_f32 v93, v158, v159
    v_cvt_pk_bf16_f32 v94, v160, v161
    v_cvt_pk_bf16_f32 v95, v162, v163
    ds_write_b128 v17, v[92:95] offset:7168
    v_cvt_pk_bf16_f32 v96, v164, v165
    v_cvt_pk_bf16_f32 v97, v166, v167
    v_cvt_pk_bf16_f32 v98, v168, v169
    v_cvt_pk_bf16_f32 v99, v170, v171
    ds_write_b128 v17, v[96:99] offset:8192
    s_cmp_lg_u32 s25, 0
    s_cbranch_scc1 K0_MM
    s_mul_i32 s36, s28, 36
    s_mul_i32 s37, s27, 9
    s_add_u32 s36, s36, s37
    s_lshl_b32 s36, s36, 10
    s_add_u32 s36, s36, 0
    v_add_u32 v19, 4096, v18
    buffer_store_dwordx4 v[64:67], v18, s[8:11], s36 offen offset:0 sc1
    buffer_store_dwordx4 v[68:71], v18, s[8:11], s36 offen offset:1024 sc1
    buffer_store_dwordx4 v[72:75], v18, s[8:11], s36 offen offset:2048 sc1
    buffer_store_dwordx4 v[76:79], v18, s[8:11], s36 offen offset:3072 sc1
    buffer_store_dwordx4 v[80:83], v19, s[8:11], s36 offen offset:0 sc1
    buffer_store_dwordx4 v[84:87], v19, s[8:11], s36 offen offset:1024 sc1
    buffer_store_dwordx4 v[88:91], v19, s[8:11], s36 offen offset:2048 sc1
    buffer_store_dwordx4 v[92:95], v19, s[8:11], s36 offen offset:3072 sc1
    v_add_u32 v19, 4096, v19
    buffer_store_dwordx4 v[96:99], v19, s[8:11], s36 offen sc1
K0_MM:
    s_waitcnt lgkmcnt(0)
    s_barrier
    s_cmp_ge_u32 s3, 6
    s_cbranch_scc1 K0_FIN
    s_mul_i32 s36, s26, 18432
    v_lshlrev_b32 v18, 4, v2
    v_add_u32 v18, s36, v18
    v_add_u32 v19, 36864, v18
    ds_read_b128 v[132:135], v18 offset:0
    ds_read_b128 v[136:139], v19 offset:0
    ds_read_b128 v[140:143], v18 offset:1024
    ds_read_b128 v[144:147], v19 offset:1024
    ds_read_b128 v[148:151], v18 offset:2048
    ds_read_b128 v[152:155], v19 offset:2048
    ds_read_b128 v[156:159], v18 offset:3072
    ds_read_b128 v[160:163], v19 offset:3072
    ds_read_b128 v[164:167], v18 offset:4096
    s_waitcnt lgkmcnt(8)
    v_mfma_f32_32x32x16_bf16 v[100:115], v[172:175], v[132:135], 0
    ds_read_b128 v[132:135], v19 offset:4096
    s_waitcnt lgkmcnt(8)
    v_mfma_f32_32x32x16_bf16 v[116:131], v[172:175], v[136:139], 0
    ds_read_b128 v[136:139], v18 offset:5120
    s_waitcnt lgkmcnt(8)
    v_mfma_f32_32x32x16_bf16 v[100:115], v[176:179], v[140:143], v[100:115]
    ds_read_b128 v[140:143], v19 offset:5120
    s_waitcnt lgkmcnt(8)
    v_mfma_f32_32x32x16_bf16 v[116:131], v[176:179], v[144:147], v[116:131]
    ds_read_b128 v[144:147], v18 offset:6144
    s_waitcnt lgkmcnt(8)
    v_mfma_f32_32x32x16_bf16 v[100:115], v[180:183], v[148:151], v[100:115]
    ds_read_b128 v[148:151], v19 offset:6144
    s_waitcnt lgkmcnt(8)
    v_mfma_f32_32x32x16_bf16 v[116:131], v[180:183], v[152:155], v[116:131]
    ds_read_b128 v[152:155], v18 offset:7168
    s_waitcnt lgkmcnt(8)
    v_mfma_f32_32x32x16_bf16 v[100:115], v[184:187], v[156:159], v[100:115]
    ds_read_b128 v[156:159], v19 offset:7168
    s_waitcnt lgkmcnt(8)
    v_mfma_f32_32x32x16_bf16 v[116:131], v[184:187], v[160:163], v[116:131]
    ds_read_b128 v[160:163], v18 offset:8192
    s_waitcnt lgkmcnt(8)
    v_mfma_f32_32x32x16_bf16 v[100:115], v[188:191], v[164:167], v[100:115]
    ds_read_b128 v[164:167], v19 offset:8192
    s_waitcnt lgkmcnt(8)
    v_mfma_f32_32x32x16_bf16 v[116:131], v[188:191], v[132:135], v[116:131]
    ds_read_b128 v[132:135], v18 offset:9216
    s_waitcnt lgkmcnt(8)
    v_mfma_f32_32x32x16_bf16 v[100:115], v[192:195], v[136:139], v[100:115]
    ds_read_b128 v[136:139], v19 offset:9216
    s_waitcnt lgkmcnt(8)
    v_mfma_f32_32x32x16_bf16 v[116:131], v[192:195], v[140:143], v[116:131]
    ds_read_b128 v[140:143], v18 offset:10240
    s_waitcnt lgkmcnt(8)
    v_mfma_f32_32x32x16_bf16 v[100:115], v[196:199], v[144:147], v[100:115]
    ds_read_b128 v[144:147], v19 offset:10240
    s_waitcnt lgkmcnt(8)
    v_mfma_f32_32x32x16_bf16 v[116:131], v[196:199], v[148:151], v[116:131]
    ds_read_b128 v[148:151], v18 offset:11264
    s_waitcnt lgkmcnt(8)
    v_mfma_f32_32x32x16_bf16 v[100:115], v[200:203], v[152:155], v[100:115]
    ds_read_b128 v[152:155], v19 offset:11264
    s_waitcnt lgkmcnt(8)
    v_mfma_f32_32x32x16_bf16 v[116:131], v[200:203], v[156:159], v[116:131]
    ds_read_b128 v[156:159], v18 offset:12288
    s_waitcnt lgkmcnt(8)
    v_mfma_f32_32x32x16_bf16 v[100:115], v[204:207], v[160:163], v[100:115]
    ds_read_b128 v[160:163], v19 offset:12288
    s_waitcnt lgkmcnt(8)
    v_mfma_f32_32x32x16_bf16 v[116:131], v[204:207], v[164:167], v[116:131]
    ds_read_b128 v[164:167], v18 offset:13312
    s_waitcnt lgkmcnt(8)
    v_mfma_f32_32x32x16_bf16 v[100:115], v[208:211], v[132:135], v[100:115]
    ds_read_b128 v[132:135], v19 offset:13312
    s_waitcnt lgkmcnt(8)
    v_mfma_f32_32x32x16_bf16 v[116:131], v[208:211], v[136:139], v[116:131]
    ds_read_b128 v[136:139], v18 offset:14336
    s_waitcnt lgkmcnt(8)
    v_mfma_f32_32x32x16_bf16 v[100:115], v[212:215], v[140:143], v[100:115]
    ds_read_b128 v[140:143], v19 offset:14336
    s_waitcnt lgkmcnt(8)
    v_mfma_f32_32x32x16_bf16 v[116:131], v[212:215], v[144:147], v[116:131]
    ds_read_b128 v[144:147], v18 offset:15360
    s_waitcnt lgkmcnt(8)
    v_mfma_f32_32x32x16_bf16 v[100:115], v[216:219], v[148:151], v[100:115]
    ds_read_b128 v[148:151], v19 offset:15360
    s_waitcnt lgkmcnt(8)
    v_mfma_f32_32x32x16_bf16 v[116:131], v[216:219], v[152:155], v[116:131]
    ds_read_b128 v[152:155], v18 offset:16384
    s_waitcnt lgkmcnt(8)
    v_mfma_f32_32x32x16_bf16 v[100:115], v[220:223], v[156:159], v[100:115]
    ds_read_b128 v[156:159], v19 offset:16384
    s_waitcnt lgkmcnt(8)
    v_mfma_f32_32x32x16_bf16 v[116:131], v[220:223], v[160:163], v[116:131]
    ds_read_b128 v[160:163], v18 offset:17408
    s_waitcnt lgkmcnt(8)
    v_mfma_f32_32x32x16_bf16 v[100:115], v[224:227], v[164:167], v[100:115]
    ds_read_b128 v[164:167], v19 offset:17408
    s_waitcnt lgkmcnt(8)
    v_mfma_f32_32x32x16_bf16 v[116:131], v[224:227], v[132:135], v[116:131]
    s_waitcnt lgkmcnt(7)
    v_mfma_f32_32x32x16_bf16 v[100:115], v[228:231], v[136:139], v[100:115]
    s_waitcnt lgkmcnt(6)
    v_mfma_f32_32x32x16_bf16 v[116:131], v[228:231], v[140:143], v[116:131]
    s_waitcnt lgkmcnt(5)
    v_mfma_f32_32x32x16_bf16 v[100:115], v[232:235], v[144:147], v[100:115]
    s_waitcnt lgkmcnt(4)
    v_mfma_f32_32x32x16_bf16 v[116:131], v[232:235], v[148:151], v[116:131]
    s_waitcnt lgkmcnt(3)
    v_mfma_f32_32x32x16_bf16 v[100:115], v[236:239], v[152:155], v[100:115]
    s_waitcnt lgkmcnt(2)
    v_mfma_f32_32x32x16_bf16 v[116:131], v[236:239], v[156:159], v[116:131]
    s_waitcnt lgkmcnt(1)
    v_mfma_f32_32x32x16_bf16 v[100:115], v[240:243], v[160:163], v[100:115]
    s_waitcnt lgkmcnt(0)
    v_mfma_f32_32x32x16_bf16 v[116:131], v[240:243], v[164:167], v[116:131]
    s_lshl_b32 s36, s27, 1
    s_add_u32 s36, s36, s26
    s_lshl_b32 s36, s36, 12
    s_add_u32 s36, s36, 81920
    v_lshlrev_b32 v18, 4, v2
    v_add_u32 v19, s36, v18
    v_xor_b32 v17, 4096, v19
    s_cmp_eq_u32 s26, 0
    s_nop 7
    s_nop 3
    s_cbranch_scc1 K0_S0
    ds_write_b128 v19, v[100:103] offset:0
    ds_write_b128 v19, v[104:107] offset:1024
    ds_write_b128 v19, v[108:111] offset:2048
    ds_write_b128 v19, v[112:115] offset:3072
    v_mov_b32 v100, v116
    v_mov_b32 v101, v117
    v_mov_b32 v102, v118
    v_mov_b32 v103, v119
    v_mov_b32 v104, v120
    v_mov_b32 v105, v121
    v_mov_b32 v106, v122
    v_mov_b32 v107, v123
    v_mov_b32 v108, v124
    v_mov_b32 v109, v125
    v_mov_b32 v110, v126
    v_mov_b32 v111, v127
    v_mov_b32 v112, v128
    v_mov_b32 v113, v129
    v_mov_b32 v114, v130
    v_mov_b32 v115, v131
    s_branch K0_S1
K0_S0:
    ds_write_b128 v19, v[116:119] offset:0
    ds_write_b128 v19, v[120:123] offset:1024
    ds_write_b128 v19, v[124:127] offset:2048
    ds_write_b128 v19, v[128:131] offset:3072
K0_S1:
K0_FIN:
    s_waitcnt lgkmcnt(0)
    s_barrier
    s_cmp_ge_u32 s3, 6
    s_cbranch_scc1 K0_GEN
    ds_read_b128 v[116:119], v17 offset:0
    ds_read_b128 v[120:123], v17 offset:1024
    ds_read_b128 v[124:127], v17 offset:2048
    ds_read_b128 v[128:131], v17 offset:3072
    s_waitcnt lgkmcnt(0)
    v_add_f32 v100, v100, v116
    v_add_f32 v101, v101, v117
    v_add_f32 v102, v102, v118
    v_add_f32 v103, v103, v119
    v_add_f32 v104, v104, v120
    v_add_f32 v105, v105, v121
    v_add_f32 v106, v106, v122
    v_add_f32 v107, v107, v123
    v_add_f32 v108, v108, v124
    v_add_f32 v109, v109, v125
    v_add_f32 v110, v110, v126
    v_add_f32 v111, v111, v127
    v_add_f32 v112, v112, v128
    v_add_f32 v113, v113, v129
    v_add_f32 v114, v114, v130
    v_add_f32 v115, v115, v131
    v_cvt_pk_bf16_f32 v20, v100, v101
    v_cvt_pk_bf16_f32 v21, v102, v103
    v_cvt_pk_bf16_f32 v22, v104, v105
    v_cvt_pk_bf16_f32 v23, v106, v107
    v_cvt_pk_bf16_f32 v24, v108, v109
    v_cvt_pk_bf16_f32 v25, v110, v111
    v_cvt_pk_bf16_f32 v26, v112, v113
    v_cvt_pk_bf16_f32 v27, v114, v115
    s_mul_i32 s36, s25, 3
    s_add_u32 s36, s36, s27
    s_lshl_b32 s36, s36, 17
    s_lshl_b32 s37, s29, 2
    s_add_u32 s36, s36, s37
    s_add_u32 s36, s36, 2359296
    v_lshlrev_b32 v18, 14, v4
    v_lshl_add_u32 v18, v3, 2, v18
    v_add_u32 v19, 8192, v18
    buffer_store_dword v20, v18, s[8:11], s36 offen sc1
    buffer_store_dword v21, v19, s[8:11], s36 offen sc1
    s_add_u32 s36, s36, 32768
    buffer_store_dword v22, v18, s[8:11], s36 offen sc1
    buffer_store_dword v23, v19, s[8:11], s36 offen sc1
    s_add_u32 s36, s36, 32768
    buffer_store_dword v24, v18, s[8:11], s36 offen sc1
    buffer_store_dword v25, v19, s[8:11], s36 offen sc1
    s_add_u32 s36, s36, 32768
    buffer_store_dword v26, v18, s[8:11], s36 offen sc1
    buffer_store_dword v27, v19, s[8:11], s36 offen sc1
    s_add_u32 s36, s36, 32768
K0_DONE:
    s_waitcnt vmcnt(0)
    s_endpgm
K0_WT:
    s_sub_u32 s24, s2, 224
    s_mov_b32 s12, s20
    s_mov_b32 s13, s21
    s_mov_b32 s14, 1183744
    s_mov_b32 s16, s22
    s_mov_b32 s17, s23
    s_mov_b32 s18, 1183744
    s_mov_b32 s19, 0x00020000
    s_mul_i32 s25, s24, 36992
    v_lshlrev_b32 v5, 4, v0
    s_lshl_b32 s26, s3, 10
    s_add_u32 m0, s26, 0
    s_add_u32 s27, s25, 0
    buffer_load_dwordx4 v5, s[12:15], s27 offen lds
    s_add_u32 m0, s26, 8192
    s_add_u32 s27, s25, 8192
    buffer_load_dwordx4 v5, s[12:15], s27 offen lds
    s_add_u32 m0, s26, 16384
    s_add_u32 s27, s25, 16384
    buffer_load_dwordx4 v5, s[12:15], s27 offen lds
    s_add_u32 m0, s26, 24576
    s_add_u32 s27, s25, 24576
    buffer_load_dwordx4 v5, s[12:15], s27 offen lds
    s_add_u32 m0, s26, 32768
    s_add_u32 s27, s25, 32768
    buffer_load_dwordx4 v5, s[12:15], s27 offen lds
    s_add_u32 m0, s26, 40960
    s_add_u32 s27, s25, 0
    buffer_load_dwordx4 v5, s[16:19], s27 offen lds
    s_add_u32 m0, s26, 49152
    s_add_u32 s27, s25, 8192
    buffer_load_dwordx4 v5, s[16:19], s27 offen lds
    s_add_u32 m0, s26, 57344
    s_add_u32 s27, s25, 16384
    buffer_load_dwordx4 v5, s[16:19], s27 offen lds
    s_add_u32 m0, s26, 65536
    s_add_u32 s27, s25, 24576
    buffer_load_dwordx4 v5, s[16:19], s27 offen lds
    s_add_u32 m0, s26, 73728
    s_add_u32 s27, s25, 32768
    buffer_load_dwordx4 v5, s[16:19], s27 offen lds
    s_lshl_b32 s28, s3, 1
    v_add_u32 v6, s28, v4
    v_mul_u32_u24 v7, 578, v3
    v_lshl_add_u32 v7, v6, 1, v7
    s_lshr_b32 s29, s24, 2
    s_lshl_b32 s29, s29, 1
    s_and_b32 s33, s24, 1
    s_add_u32 s29, s29, s33
    s_lshl_b32 s29, s29, 9
    s_bfe_u32 s33, s24, 0x10001
    s_lshl_b32 s33, s33, 8
    s_add_u32 s29, s29, s33
    s_add_u32 s29, s29, 5111808
    v_lshlrev_b32 v8, 13, v6
    v_lshl_add_u32 v8, v3, 3, v8
    s_waitcnt vmcnt(0)
    s_barrier
    s_movk_i32 s44, 296
    s_mov_b32 s34, 0
K0_WL:
    ds_read_u16 v10, v7
    ds_read_u16 v12, v7 offset:40960
    ds_read_u16 v11, v7 offset:18496
    ds_read_u16 v13, v7 offset:59456
    v_cmp_gt_u32 vcc, 289, v6
    v_cmp_gt_u32 s[40:41], s44, v6
    s_waitcnt lgkmcnt(0)
    v_lshl_or_b32 v10, v12, 16, v10
    v_lshl_or_b32 v11, v13, 16, v11
    v_cndmask_b32 v10, 0, v10, vcc
    v_cndmask_b32 v11, 0, v11, vcc
    s_and_saveexec_b64 s[42:43], s[40:41]
    buffer_store_dwordx2 v[10:11], v8, s[8:11], s29 offen sc1
    s_mov_b64 exec, s[42:43]
    v_add_u32 v6, 16, v6
    v_add_u32 v7, 32, v7
    v_add_u32 v8, 131072, v8
    s_add_u32 s34, s34, 1
    s_cmp_lt_u32 s34, 19
    s_cbranch_scc1 K0_WL
    s_waitcnt vmcnt(0)
K0_END:
    s_endpgm
.globl k1_kernel
.p2align 8
.type k1_kernel,@function
k1_kernel:
    s_cmp_ge_u32 s2, 256
    s_cbranch_scc1 K1_END
    s_load_dwordx2 s[6:7], s[0:1], 72
    s_load_dwordx4 s[20:23], s[0:1], 32
    v_lshrrev_b32 v1, 6, v0
    v_and_b32 v2, 63, v0
    s_nop 0
    v_readfirstlane_b32 s3, v1
    s_and_b32 s24, s2, 7
    s_lshl_b32 s24, s24, 2
    s_bfe_u32 s25, s2, 0x20003
    s_add_u32 s24, s24, s25
    s_lshr_b32 s25, s2, 5
    s_mov_b32 s46, 0xbdd2d3e8
    s_mov_b32 s47, 0xc0135761
    s_waitcnt lgkmcnt(0)
    s_mov_b32 s8, s6
    s_mov_b32 s9, s7
    s_mov_b32 s10, 268435456
    s_mov_b32 s11, 0x00020000
    s_mov_b32 s12, s20
    s_mov_b32 s13, s21
    s_mov_b32 s14, 5308416
    s_mov_b32 s15, 0x00020000
    s_mov_b32 s16, s22
    s_mov_b32 s17, s23
    s_mov_b32 s18, 5308416
    s_mov_b32 s19, 0x00020000
    v_bfe_u32 v3, v2, 4, 1
    v_lshrrev_b32 v4, 5, v2
    v_bfe_u32 v5, v2, 2, 2
    v_and_b32 v6, 1, v2
    v_bfe_u32 v7, v2, 1, 1
    v_lshlrev_b32 v6, 4, v6
    v_lshl_or_b32 v6, v7, 3, v6
    v_lshl_add_u32 v5, v4, 3, v5
    v_mul_u32_u24 v5, 288, v5
    v_add_u32 v5, v5, v6
    v_mul_u32_u24 v3, 9344, v3
    v_add_u32 v5, v5, v3
    v_add_u32 v11, 16384, v5
    s_and_b32 s26, s3, 3
    s_lshr_b32 s27, s3, 2
    s_mul_i32 s28, s27, 160
    v_add_u32 v11, s28, v11
    v_mov_b32 v10, v11
    v_lshlrev_b32 v13, 4, v2
    s_lshl_b32 s28, s26, 12
    v_add_u32 v13, s28, v13
    v_mov_b32 v12, v13
    s_mov_b32 s30, 0
    s_mov_b32 s32, 0
    s_cmp_eq_u32 s27, 1
    s_cbranch_scc1 K1_B
    s_lshl_b32 s33, s25, 3
    s_lshl_b32 s34, s26, 1
    s_add_u32 s33, s33, s34
    s_mul_i32 s33, s33, 36864
    s_add_u32 s33, s33, 0
    v_lshlrev_b32 v14, 4, v2
    v_add_u32 v15, 36864, v14
    s_lshl_b32 s35, s26, 12
    s_add_u32 s36, s32, s35
    s_add_u32 m0, s36, 0
    s_nop 0
    buffer_load_dwordx4 v14, s[8:11], s33 offen lds
    s_add_u32 m0, s36, 1024
    s_add_u32 s37, s33, 1024
    buffer_load_dwordx4 v14, s[8:11], s37 offen lds
    s_add_u32 m0, s36, 2048
    s_nop 0
    buffer_load_dwordx4 v15, s[8:11], s33 offen lds
    s_add_u32 m0, s36, 3072
    s_add_u32 s37, s33, 1024
    buffer_load_dwordx4 v15, s[8:11], s37 offen lds
    s_add_u32 s33, s33, 2048
    s_add_u32 s32, s32, 35072
    s_cmp_eq_u32 s32, 140288
    s_cselect_b32 s32, 0, s32
    s_add_u32 s36, s32, s35
    s_add_u32 m0, s36, 0
    s_nop 0
    buffer_load_dwordx4 v14, s[8:11], s33 offen lds
    s_add_u32 m0, s36, 1024
    s_add_u32 s37, s33, 1024
    buffer_load_dwordx4 v14, s[8:11], s37 offen lds
    s_add_u32 m0, s36, 2048
    s_nop 0
    buffer_load_dwordx4 v15, s[8:11], s33 offen lds
    s_add_u32 m0, s36, 3072
    s_add_u32 s37, s33, 1024
    buffer_load_dwordx4 v15, s[8:11], s37 offen lds
    s_add_u32 s33, s33, 2048
    s_add_u32 s32, s32, 35072
    s_cmp_eq_u32 s32, 140288
    s_cselect_b32 s32, 0, s32
    s_add_u32 s36, s32, s35
    s_add_u32 m0, s36, 0
    s_nop 0
    buffer_load_dwordx4 v14, s[8:11], s33 offen lds
    s_add_u32 m0, s36, 1024
    s_add_u32 s37, s33, 1024
    buffer_load_dwordx4 v14, s[8:11], s37 offen lds
    s_add_u32 m0, s36, 2048
    s_nop 0
    buffer_load_dwordx4 v15, s[8:11], s33 offen lds
    s_add_u32 m0, s36, 3072
    s_add_u32 s37, s33, 1024
    buffer_load_dwordx4 v15, s[8:11], s37 offen lds
    s_add_u32 s33, s33, 2048
    s_add_u32 s32, s32, 35072
    s_cmp_eq_u32 s32, 140288
    s_cselect_b32 s32, 0, s32
    s_add_u32 s36, s32, s35
    s_add_u32 m0, s36, 0
    s_nop 0
    buffer_load_dwordx4 v14, s[8:11], s33 offen lds
    s_add_u32 m0, s36, 1024
    s_add_u32 s37, s33, 1024
    buffer_load_dwordx4 v14, s[8:11], s37 offen lds
    s_add_u32 m0, s36, 2048
    s_nop 0
    buffer_load_dwordx4 v15, s[8:11], s33 offen lds
    s_add_u32 m0, s36, 3072
    s_add_u32 s37, s33, 1024
    buffer_load_dwordx4 v15, s[8:11], s37 offen lds
    s_add_u32 s33, s33, 2048
    s_add_u32 s32, s32, 35072
    s_cmp_eq_u32 s32, 140288
    s_cselect_b32 s32, 0, s32
    v_mov_b32 v96, 0
    v_mov_b32 v97, 0
    v_mov_b32 v98, 0
    v_mov_b32 v99, 0
    v_mov_b32 v100, 0
    v_mov_b32 v101, 0
    v_mov_b32 v102, 0
    v_mov_b32 v103, 0
    v_mov_b32 v104, 0
    v_mov_b32 v105, 0
    v_mov_b32 v106, 0
    v_mov_b32 v107, 0
    v_mov_b32 v108, 0
    v_mov_b32 v109, 0
    v_mov_b32 v110, 0
    v_mov_b32 v111, 0
    v_mov_b32 v112, 0
    v_mov_b32 v113, 0
    v_mov_b32 v114, 0
    v_mov_b32 v115, 0
    v_mov_b32 v116, 0
    v_mov_b32 v117, 0
    v_mov_b32 v118, 0
    v_mov_b32 v119, 0
    v_mov_b32 v120, 0
    v_mov_b32 v121, 0
    v_mov_b32 v122, 0
    v_mov_b32 v123, 0
    v_mov_b32 v124, 0
    v_mov_b32 v125, 0
    v_mov_b32 v126, 0
    v_mov_b32 v127, 0
    v_mov_b32 v128, 0
    v_mov_b32 v129, 0
    v_mov_b32 v130, 0
    v_mov_b32 v131, 0
    v_mov_b32 v132, 0
    v_mov_b32 v133, 0
    v_mov_b32 v134, 0
    v_mov_b32 v135, 0
    v_mov_b32 v136, 0
    v_mov_b32 v137, 0
    v_mov_b32 v138, 0
    v_mov_b32 v139, 0
    v_mov_b32 v140, 0
    v_mov_b32 v141, 0
    v_mov_b32 v142, 0
    v_mov_b32 v143, 0
    v_mov_b32 v144, 0
    v_mov_b32 v145, 0
    v_mov_b32 v146, 0
    v_mov_b32 v147, 0
    v_mov_b32 v148, 0
    v_mov_b32 v149, 0
    v_mov_b32 v150, 0
    v_mov_b32 v151, 0
    v_mov_b32 v152, 0
    v_mov_b32 v153, 0
    v_mov_b32 v154, 0
    v_mov_b32 v155, 0
    v_mov_b32 v156, 0
    v_mov_b32 v157, 0
    v_mov_b32 v158, 0
    v_mov_b32 v159, 0
    v_mov_b32 v160, 0
    v_mov_b32 v161, 0
    v_mov_b32 v162, 0
    v_mov_b32 v163, 0
    v_mov_b32 v164, 0
    v_mov_b32 v165, 0
    v_mov_b32 v166, 0
    v_mov_b32 v167, 0
    v_mov_b32 v168, 0
    v_mov_b32 v169, 0
    v_mov_b32 v170, 0
    v_mov_b32 v171, 0
    v_mov_b32 v172, 0
    v_mov_b32 v173, 0
    v_mov_b32 v174, 0
    v_mov_b32 v175, 0
    v_mov_b32 v176, 0
    v_mov_b32 v177, 0
    v_mov_b32 v178, 0
    v_mov_b32 v179, 0
    v_mov_b32 v180, 0
    v_mov_b32 v181, 0
    v_mov_b32 v182, 0
    v_mov_b32 v183, 0
    v_mov_b32 v184, 0
    v_mov_b32 v185, 0
    v_mov_b32 v186, 0
    v_mov_b32 v187, 0
    v_mov_b32 v188, 0
    v_mov_b32 v189, 0
    v_mov_b32 v190, 0
    v_mov_b32 v191, 0
    v_mov_b32 v192, 0
    v_mov_b32 v193, 0
    v_mov_b32 v194, 0
    v_mov_b32 v195, 0
    v_mov_b32 v196, 0
    v_mov_b32 v197, 0
    v_mov_b32 v198, 0
    v_mov_b32 v199, 0
    v_mov_b32 v200, 0
    v_mov_b32 v201, 0
    v_mov_b32 v202, 0
    v_mov_b32 v203, 0
    v_mov_b32 v204, 0
    v_mov_b32 v205, 0
    v_mov_b32 v206, 0
    v_mov_b32 v207, 0
    v_mov_b32 v208, 0
    v_mov_b32 v209, 0
    v_mov_b32 v210, 0
    v_mov_b32 v211, 0
    v_mov_b32 v212, 0
    v_mov_b32 v213, 0
    v_mov_b32 v214, 0
    v_mov_b32 v215, 0
    v_mov_b32 v216, 0
    v_mov_b32 v217, 0
    v_mov_b32 v218, 0
    v_mov_b32 v219, 0
    v_mov_b32 v220, 0
    v_mov_b32 v221, 0
    v_mov_b32 v222, 0
    v_mov_b32 v223, 0
    v_mov_b32 v224, 0
    v_mov_b32 v225, 0
    v_mov_b32 v226, 0
    v_mov_b32 v227, 0
    v_mov_b32 v228, 0
    v_mov_b32 v229, 0
    v_mov_b32 v230, 0
    v_mov_b32 v231, 0
    v_mov_b32 v232, 0
    v_mov_b32 v233, 0
    v_mov_b32 v234, 0
    v_mov_b32 v235, 0
    v_mov_b32 v236, 0
    v_mov_b32 v237, 0
    v_mov_b32 v238, 0
    v_mov_b32 v239, 0
    v_mov_b32 v240, 0
    v_mov_b32 v241, 0
    v_mov_b32 v242, 0
    v_mov_b32 v243, 0
    v_mov_b32 v244, 0
    v_mov_b32 v245, 0
    v_mov_b32 v246, 0
    v_mov_b32 v247, 0
    v_mov_b32 v248, 0
    v_mov_b32 v249, 0
    v_mov_b32 v250, 0
    v_mov_b32 v251, 0
    v_mov_b32 v252, 0
    v_mov_b32 v253, 0
    v_mov_b32 v254, 0
    v_mov_b32 v255, 0
    s_waitcnt vmcnt(12)
    s_barrier
    ds_read_b128 v[24:27], v12 offset:0
    ds_read_b128 v[28:31], v12 offset:2048
    ds_read_b64_tr_b16 v[40:41], v10 offset:0
    ds_read_b64_tr_b16 v[42:43], v10 offset:1152
    ds_read_b64_tr_b16 v[44:45], v10 offset:32
    ds_read_b64_tr_b16 v[46:47], v10 offset:1184
    ds_read_b64_tr_b16 v[48:49], v10 offset:64
    ds_read_b64_tr_b16 v[50:51], v10 offset:1216
    ds_read_b64_tr_b16 v[52:53], v10 offset:96
    ds_read_b64_tr_b16 v[54:55], v10 offset:1248
    ds_read_b64_tr_b16 v[56:57], v10 offset:128
    ds_read_b64_tr_b16 v[58:59], v10 offset:1280
    s_mov_b32 s31, 0
K1A_LOOP:
    s_waitcnt lgkmcnt(0)
    v_mfma_f32_32x32x16_bf16 v[96:111], v[40:43], v[24:27], v[96:111]
    ds_read_b128 v[32:35], v12 offset:1024
    ds_read_b128 v[36:39], v12 offset:3072
    v_mfma_f32_32x32x16_bf16 v[112:127], v[40:43], v[28:31], v[112:127]
    ds_read_b64_tr_b16 v[60:61], v10 offset:4608
    v_mfma_f32_32x32x16_bf16 v[128:143], v[44:47], v[24:27], v[128:143]
    ds_read_b64_tr_b16 v[62:63], v10 offset:5760
    v_mfma_f32_32x32x16_bf16 v[144:159], v[44:47], v[28:31], v[144:159]
    ds_read_b64_tr_b16 v[64:65], v10 offset:4640
    v_mfma_f32_32x32x16_bf16 v[160:175], v[48:51], v[24:27], v[160:175]
    ds_read_b64_tr_b16 v[66:67], v10 offset:5792
    v_mfma_f32_32x32x16_bf16 v[176:191], v[48:51], v[28:31], v[176:191]
    ds_read_b64_tr_b16 v[68:69], v10 offset:4672
    ds_read_b64_tr_b16 v[70:71], v10 offset:5824
    v_mfma_f32_32x32x16_bf16 v[192:207], v[52:55], v[24:27], v[192:207]
    ds_read_b64_tr_b16 v[72:73], v10 offset:4704
    v_mfma_f32_32x32x16_bf16 v[208:223], v[52:55], v[28:31], v[208:223]
    ds_read_b64_tr_b16 v[74:75], v10 offset:5856
    v_mfma_f32_32x32x16_bf16 v[224:239], v[56:59], v[24:27], v[224:239]
    ds_read_b64_tr_b16 v[76:77], v10 offset:4736
    v_mfma_f32_32x32x16_bf16 v[240:255], v[56:59], v[28:31], v[240:255]
    ds_read_b64_tr_b16 v[78:79], v10 offset:5888
    s_add_u32 s30, s30, 35072
    s_cmp_eq_u32 s30, 140288
    s_cselect_b32 s30, 0, s30
    s_waitcnt vmcnt(8) lgkmcnt(0)
    s_barrier
    v_add_u32 v10, s30, v11
    v_add_u32 v12, s30, v13
    v_mfma_f32_32x32x16_bf16 v[96:111], v[60:63], v[32:35], v[96:111]
    ds_read_b128 v[24:27], v12 offset:0
    ds_read_b128 v[28:31], v12 offset:2048
    s_cmp_lt_u32 s31, 14
    s_cselect_b32 s10, 268435456, 0
    s_cselect_b32 s14, 5308416, 0
    s_cselect_b32 s18, 5308416, 0
    v_mfma_f32_32x32x16_bf16 v[112:127], v[60:63], v[36:39], v[112:127]
    s_add_u32 s36, s32, s35
    s_add_u32 m0, s36, 0
    s_nop 0
    buffer_load_dwordx4 v14, s[8:11], s33 offen lds
    v_mfma_f32_32x32x16_bf16 v[128:143], v[64:67], v[32:35], v[128:143]
    s_add_u32 m0, s36, 1024
    s_add_u32 s37, s33, 1024
    buffer_load_dwordx4 v14, s[8:11], s37 offen lds
    v_mfma_f32_32x32x16_bf16 v[144:159], v[64:67], v[36:39], v[144:159]
    s_add_u32 m0, s36, 2048
    s_nop 0
    buffer_load_dwordx4 v15, s[8:11], s33 offen lds
    s_add_u32 m0, s36, 3072
    v_mfma_f32_32x32x16_bf16 v[160:175], v[68:71], v[32:35], v[160:175]
    s_add_u32 s37, s33, 1024
    buffer_load_dwordx4 v15, s[8:11], s37 offen lds
    s_add_u32 s33, s33, 2048
    v_mfma_f32_32x32x16_bf16 v[176:191], v[68:71], v[36:39], v[176:191]
    s_add_u32 s32, s32, 35072
    s_cmp_eq_u32 s32, 140288
    s_cselect_b32 s32, 0, s32
    v_mfma_f32_32x32x16_bf16 v[192:207], v[72:75], v[32:35], v[192:207]
    ds_read_b64_tr_b16 v[40:41], v10 offset:0
    ds_read_b64_tr_b16 v[42:43], v10 offset:1152
    ds_read_b64_tr_b16 v[44:45], v10 offset:32
    v_mfma_f32_32x32x16_bf16 v[208:223], v[72:75], v[36:39], v[208:223]
    ds_read_b64_tr_b16 v[46:47], v10 offset:1184
    ds_read_b64_tr_b16 v[48:49], v10 offset:64
    v_mfma_f32_32x32x16_bf16 v[224:239], v[76:79], v[32:35], v[224:239]
    ds_read_b64_tr_b16 v[50:51], v10 offset:1216
    ds_read_b64_tr_b16 v[52:53], v10 offset:96
    ds_read_b64_tr_b16 v[54:55], v10 offset:1248
    v_mfma_f32_32x32x16_bf16 v[240:255], v[76:79], v[36:39], v[240:255]
    ds_read_b64_tr_b16 v[56:57], v10 offset:128
    ds_read_b64_tr_b16 v[58:59], v10 offset:1280
    s_add_u32 s31, s31, 1
    s_cmp_lt_u32 s31, 18
    s_cbranch_scc1 K1A_LOOP
    s_mov_b32 s10, 268435456
    s_mov_b32 s14, 5308416
    s_mov_b32 s18, 5308416
    s_waitcnt lgkmcnt(0)
    s_lshl_b32 s33, s25, 3
    s_lshl_b32 s34, s26, 1
    s_add_u32 s33, s33, s34
    s_mul_i32 s33, s33, 288
    s_mul_i32 s34, s24, 9
    s_add_u32 s33, s33, s34
    s_add_u32 s33, s33, 0
    s_lshl_b32 s33, s33, 10
    s_add_u32 s33, s33, 16777216
    v_lshlrev_b32 v14, 4, v2
    v_mov_b32 v52, s47
    s_nop 7
    v_pk_mul_f32 v[24:25], v[96:97], v[96:97]
    v_pk_mul_f32 v[28:29], v[98:99], v[98:99]
    v_pk_mul_f32 v[32:33], v[100:101], v[100:101]
    v_pk_mul_f32 v[36:37], v[102:103], v[102:103]
    v_pk_fma_f32 v[24:25], v[24:25], s[46:47], v[52:53] op_sel_hi:[1,0,0]
    v_pk_fma_f32 v[28:29], v[28:29], s[46:47], v[52:53] op_sel_hi:[1,0,0]
    v_pk_fma_f32 v[32:33], v[32:33], s[46:47], v[52:53] op_sel_hi:[1,0,0]
    v_pk_fma_f32 v[36:37], v[36:37], s[46:47], v[52:53] op_sel_hi:[1,0,0]
    v_pk_mul_f32 v[24:25], v[24:25], v[96:97]
    v_pk_mul_f32 v[28:29], v[28:29], v[98:99]
    v_pk_mul_f32 v[32:33], v[32:33], v[100:101]
    v_pk_mul_f32 v[36:37], v[36:37], v[102:103]
    v_exp_f32 v24, v24
    v_exp_f32 v25, v25
    v_exp_f32 v28, v28
    v_exp_f32 v29, v29
    v_exp_f32 v32, v32
    v_exp_f32 v33, v33
    v_exp_f32 v36, v36
    v_exp_f32 v37, v37
    v_pk_mul_f32 v[26:27], v[96:97], v[104:105]
    v_pk_mul_f32 v[30:31], v[98:99], v[106:107]
    v_pk_mul_f32 v[34:35], v[100:101], v[108:109]
    v_pk_mul_f32 v[38:39], v[102:103], v[110:111]
    v_pk_add_f32 v[24:25], v[24:25], 1.0 op_sel_hi:[1,0]
    v_pk_add_f32 v[28:29], v[28:29], 1.0 op_sel_hi:[1,0]
    v_pk_add_f32 v[32:33], v[32:33], 1.0 op_sel_hi:[1,0]
    v_pk_add_f32 v[36:37], v[36:37], 1.0 op_sel_hi:[1,0]
    v_rcp_f32 v24, v24
    v_rcp_f32 v25, v25
    v_rcp_f32 v28, v28
    v_rcp_f32 v29, v29
    v_rcp_f32 v32, v32
    v_rcp_f32 v33, v33
    v_rcp_f32 v36, v36
    v_rcp_f32 v37, v37
    v_pk_mul_f32 v[96:97], v[26:27], v[24:25]
    v_pk_mul_f32 v[98:99], v[30:31], v[28:29]
    v_pk_mul_f32 v[100:101], v[34:35], v[32:33]
    v_pk_mul_f32 v[102:103], v[38:39], v[36:37]
    v_cvt_pk_bf16_f32 v44, v96, v97
    v_cvt_pk_bf16_f32 v45, v98, v99
    v_cvt_pk_bf16_f32 v46, v100, v101
    v_cvt_pk_bf16_f32 v47, v102, v103
    s_add_u32 s34, s33, 0
    buffer_store_dwordx4 v[44:47], v14, s[8:11], s34 offen sc1
    v_pk_mul_f32 v[24:25], v[112:113], v[112:113]
    v_pk_mul_f32 v[28:29], v[114:115], v[114:115]
    v_pk_mul_f32 v[32:33], v[116:117], v[116:117]
    v_pk_mul_f32 v[36:37], v[118:119], v[118:119]
    v_pk_fma_f32 v[24:25], v[24:25], s[46:47], v[52:53] op_sel_hi:[1,0,0]
    v_pk_fma_f32 v[28:29], v[28:29], s[46:47], v[52:53] op_sel_hi:[1,0,0]
    v_pk_fma_f32 v[32:33], v[32:33], s[46:47], v[52:53] op_sel_hi:[1,0,0]
    v_pk_fma_f32 v[36:37], v[36:37], s[46:47], v[52:53] op_sel_hi:[1,0,0]
    v_pk_mul_f32 v[24:25], v[24:25], v[112:113]
    v_pk_mul_f32 v[28:29], v[28:29], v[114:115]
    v_pk_mul_f32 v[32:33], v[32:33], v[116:117]
    v_pk_mul_f32 v[36:37], v[36:37], v[118:119]
    v_exp_f32 v24, v24
    v_exp_f32 v25, v25
    v_exp_f32 v28, v28
    v_exp_f32 v29, v29
    v_exp_f32 v32, v32
    v_exp_f32 v33, v33
    v_exp_f32 v36, v36
    v_exp_f32 v37, v37
    v_pk_mul_f32 v[26:27], v[112:113], v[120:121]
    v_pk_mul_f32 v[30:31], v[114:115], v[122:123]
    v_pk_mul_f32 v[34:35], v[116:117], v[124:125]
    v_pk_mul_f32 v[38:39], v[118:119], v[126:127]
    v_pk_add_f32 v[24:25], v[24:25], 1.0 op_sel_hi:[1,0]
    v_pk_add_f32 v[28:29], v[28:29], 1.0 op_sel_hi:[1,0]
    v_pk_add_f32 v[32:33], v[32:33], 1.0 op_sel_hi:[1,0]
    v_pk_add_f32 v[36:37], v[36:37], 1.0 op_sel_hi:[1,0]
    v_rcp_f32 v24, v24
    v_rcp_f32 v25, v25
    v_rcp_f32 v28, v28
    v_rcp_f32 v29, v29
    v_rcp_f32 v32, v32
    v_rcp_f32 v33, v33
    v_rcp_f32 v36, v36
    v_rcp_f32 v37, v37
    v_pk_mul_f32 v[112:113], v[26:27], v[24:25]
    v_pk_mul_f32 v[114:115], v[30:31], v[28:29]
    v_pk_mul_f32 v[116:117], v[34:35], v[32:33]
    v_pk_mul_f32 v[118:119], v[38:39], v[36:37]
    v_cvt_pk_bf16_f32 v48, v112, v113
    v_cvt_pk_bf16_f32 v49, v114, v115
    v_cvt_pk_bf16_f32 v50, v116, v117
    v_cvt_pk_bf16_f32 v51, v118, v119
    s_add_u32 s34, s33, 294912
    buffer_store_dwordx4 v[48:51], v14, s[8:11], s34 offen sc1
    v_pk_mul_f32 v[24:25], v[128:129], v[128:129]
    v_pk_mul_f32 v[28:29], v[130:131], v[130:131]
    v_pk_mul_f32 v[32:33], v[132:133], v[132:133]
    v_pk_mul_f32 v[36:37], v[134:135], v[134:135]
    v_pk_fma_f32 v[24:25], v[24:25], s[46:47], v[52:53] op_sel_hi:[1,0,0]
    v_pk_fma_f32 v[28:29], v[28:29], s[46:47], v[52:53] op_sel_hi:[1,0,0]
    v_pk_fma_f32 v[32:33], v[32:33], s[46:47], v[52:53] op_sel_hi:[1,0,0]
    v_pk_fma_f32 v[36:37], v[36:37], s[46:47], v[52:53] op_sel_hi:[1,0,0]
    v_pk_mul_f32 v[24:25], v[24:25], v[128:129]
    v_pk_mul_f32 v[28:29], v[28:29], v[130:131]
    v_pk_mul_f32 v[32:33], v[32:33], v[132:133]
    v_pk_mul_f32 v[36:37], v[36:37], v[134:135]
    v_exp_f32 v24, v24
    v_exp_f32 v25, v25
    v_exp_f32 v28, v28
    v_exp_f32 v29, v29
    v_exp_f32 v32, v32
    v_exp_f32 v33, v33
    v_exp_f32 v36, v36
    v_exp_f32 v37, v37
    v_pk_mul_f32 v[26:27], v[128:129], v[136:137]
    v_pk_mul_f32 v[30:31], v[130:131], v[138:139]
    v_pk_mul_f32 v[34:35], v[132:133], v[140:141]
    v_pk_mul_f32 v[38:39], v[134:135], v[142:143]
    v_pk_add_f32 v[24:25], v[24:25], 1.0 op_sel_hi:[1,0]
    v_pk_add_f32 v[28:29], v[28:29], 1.0 op_sel_hi:[1,0]
    v_pk_add_f32 v[32:33], v[32:33], 1.0 op_sel_hi:[1,0]
    v_pk_add_f32 v[36:37], v[36:37], 1.0 op_sel_hi:[1,0]
    v_rcp_f32 v24, v24
    v_rcp_f32 v25, v25
    v_rcp_f32 v28, v28
    v_rcp_f32 v29, v29
    v_rcp_f32 v32, v32
    v_rcp_f32 v33, v33
    v_rcp_f32 v36, v36
    v_rcp_f32 v37, v37
    v_pk_mul_f32 v[128:129], v[26:27], v[24:25]
    v_pk_mul_f32 v[130:131], v[30:31], v[28:29]
    v_pk_mul_f32 v[132:133], v[34:35], v[32:33]
    v_pk_mul_f32 v[134:135], v[38:39], v[36:37]
    v_cvt_pk_bf16_f32 v44, v128, v129
    v_cvt_pk_bf16_f32 v45, v130, v131
    v_cvt_pk_bf16_f32 v46, v132, v133
    v_cvt_pk_bf16_f32 v47, v134, v135
    s_add_u32 s34, s33, 1024
    buffer_store_dwordx4 v[44:47], v14, s[8:11], s34 offen sc1
    v_pk_mul_f32 v[24:25], v[144:145], v[144:145]
    v_pk_mul_f32 v[28:29], v[146:147], v[146:147]
    v_pk_mul_f32 v[32:33], v[148:149], v[148:149]
    v_pk_mul_f32 v[36:37], v[150:151], v[150:151]
    v_pk_fma_f32 v[24:25], v[24:25], s[46:47], v[52:53] op_sel_hi:[1,0,0]
    v_pk_fma_f32 v[28:29], v[28:29], s[46:47], v[52:53] op_sel_hi:[1,0,0]
    v_pk_fma_f32 v[32:33], v[32:33], s[46:47], v[52:53] op_sel_hi:[1,0,0]
    v_pk_fma_f32 v[36:37], v[36:37], s[46:47], v[52:53] op_sel_hi:[1,0,0]
    v_pk_mul_f32 v[24:25], v[24:25], v[144:145]
    v_pk_mul_f32 v[28:29], v[28:29], v[146:147]
    v_pk_mul_f32 v[32:33], v[32:33], v[148:149]
    v_pk_mul_f32 v[36:37], v[36:37], v[150:151]
    v_exp_f32 v24, v24
    v_exp_f32 v25, v25
    v_exp_f32 v28, v28
    v_exp_f32 v29, v29
    v_exp_f32 v32, v32
    v_exp_f32 v33, v33
    v_exp_f32 v36, v36
    v_exp_f32 v37, v37
    v_pk_mul_f32 v[26:27], v[144:145], v[152:153]
    v_pk_mul_f32 v[30:31], v[146:147], v[154:155]
    v_pk_mul_f32 v[34:35], v[148:149], v[156:157]
    v_pk_mul_f32 v[38:39], v[150:151], v[158:159]
    v_pk_add_f32 v[24:25], v[24:25], 1.0 op_sel_hi:[1,0]
    v_pk_add_f32 v[28:29], v[28:29], 1.0 op_sel_hi:[1,0]
    v_pk_add_f32 v[32:33], v[32:33], 1.0 op_sel_hi:[1,0]
    v_pk_add_f32 v[36:37], v[36:37], 1.0 op_sel_hi:[1,0]
    v_rcp_f32 v24, v24
    v_rcp_f32 v25, v25
    v_rcp_f32 v28, v28
    v_rcp_f32 v29, v29
    v_rcp_f32 v32, v32
    v_rcp_f32 v33, v33
    v_rcp_f32 v36, v36
    v_rcp_f32 v37, v37
    v_pk_mul_f32 v[144:145], v[26:27], v[24:25]
    v_pk_mul_f32 v[146:147], v[30:31], v[28:29]
    v_pk_mul_f32 v[148:149], v[34:35], v[32:33]
    v_pk_mul_f32 v[150:151], v[38:39], v[36:37]
    v_cvt_pk_bf16_f32 v48, v144, v145
    v_cvt_pk_bf16_f32 v49, v146, v147
    v_cvt_pk_bf16_f32 v50, v148, v149
    v_cvt_pk_bf16_f32 v51, v150, v151
    s_add_u32 s34, s33, 295936
    buffer_store_dwordx4 v[48:51], v14, s[8:11], s34 offen sc1
    v_pk_mul_f32 v[24:25], v[160:161], v[160:161]
    v_pk_mul_f32 v[28:29], v[162:163], v[162:163]
    v_pk_mul_f32 v[32:33], v[164:165], v[164:165]
    v_pk_mul_f32 v[36:37], v[166:167], v[166:167]
    v_pk_fma_f32 v[24:25], v[24:25], s[46:47], v[52:53] op_sel_hi:[1,0,0]
    v_pk_fma_f32 v[28:29], v[28:29], s[46:47], v[52:53] op_sel_hi:[1,0,0]
    v_pk_fma_f32 v[32:33], v[32:33], s[46:47], v[52:53] op_sel_hi:[1,0,0]
    v_pk_fma_f32 v[36:37], v[36:37], s[46:47], v[52:53] op_sel_hi:[1,0,0]
    v_pk_mul_f32 v[24:25], v[24:25], v[160:161]
    v_pk_mul_f32 v[28:29], v[28:29], v[162:163]
    v_pk_mul_f32 v[32:33], v[32:33], v[164:165]
    v_pk_mul_f32 v[36:37], v[36:37], v[166:167]
    v_exp_f32 v24, v24
    v_exp_f32 v25, v25
    v_exp_f32 v28, v28
    v_exp_f32 v29, v29
    v_exp_f32 v32, v32
    v_exp_f32 v33, v33
    v_exp_f32 v36, v36
    v_exp_f32 v37, v37
    v_pk_mul_f32 v[26:27], v[160:161], v[168:169]
    v_pk_mul_f32 v[30:31], v[162:163], v[170:171]
    v_pk_mul_f32 v[34:35], v[164:165], v[172:173]
    v_pk_mul_f32 v[38:39], v[166:167], v[174:175]
    v_pk_add_f32 v[24:25], v[24:25], 1.0 op_sel_hi:[1,0]
    v_pk_add_f32 v[28:29], v[28:29], 1.0 op_sel_hi:[1,0]
    v_pk_add_f32 v[32:33], v[32:33], 1.0 op_sel_hi:[1,0]
    v_pk_add_f32 v[36:37], v[36:37], 1.0 op_sel_hi:[1,0]
    v_rcp_f32 v24, v24
    v_rcp_f32 v25, v25
    v_rcp_f32 v28, v28
    v_rcp_f32 v29, v29
    v_rcp_f32 v32, v32
    v_rcp_f32 v33, v33
    v_rcp_f32 v36, v36
    v_rcp_f32 v37, v37
    v_pk_mul_f32 v[160:161], v[26:27], v[24:25]
    v_pk_mul_f32 v[162:163], v[30:31], v[28:29]
    v_pk_mul_f32 v[164:165], v[34:35], v[32:33]
    v_pk_mul_f32 v[166:167], v[38:39], v[36:37]
    v_cvt_pk_bf16_f32 v44, v160, v161
    v_cvt_pk_bf16_f32 v45, v162, v163
    v_cvt_pk_bf16_f32 v46, v164, v165
    v_cvt_pk_bf16_f32 v47, v166, v167
    s_add_u32 s34, s33, 2048
    buffer_store_dwordx4 v[44:47], v14, s[8:11], s34 offen sc1
    v_pk_mul_f32 v[24:25], v[176:177], v[176:177]
    v_pk_mul_f32 v[28:29], v[178:179], v[178:179]
    v_pk_mul_f32 v[32:33], v[180:181], v[180:181]
    v_pk_mul_f32 v[36:37], v[182:183], v[182:183]
    v_pk_fma_f32 v[24:25], v[24:25], s[46:47], v[52:53] op_sel_hi:[1,0,0]
    v_pk_fma_f32 v[28:29], v[28:29], s[46:47], v[52:53] op_sel_hi:[1,0,0]
    v_pk_fma_f32 v[32:33], v[32:33], s[46:47], v[52:53] op_sel_hi:[1,0,0]
    v_pk_fma_f32 v[36:37], v[36:37], s[46:47], v[52:53] op_sel_hi:[1,0,0]
    v_pk_mul_f32 v[24:25], v[24:25], v[176:177]
    v_pk_mul_f32 v[28:29], v[28:29], v[178:179]
    v_pk_mul_f32 v[32:33], v[32:33], v[180:181]
    v_pk_mul_f32 v[36:37], v[36:37], v[182:183]
    v_exp_f32 v24, v24
    v_exp_f32 v25, v25
    v_exp_f32 v28, v28
    v_exp_f32 v29, v29
    v_exp_f32 v32, v32
    v_exp_f32 v33, v33
    v_exp_f32 v36, v36
    v_exp_f32 v37, v37
    v_pk_mul_f32 v[26:27], v[176:177], v[184:185]
    v_pk_mul_f32 v[30:31], v[178:179], v[186:187]
    v_pk_mul_f32 v[34:35], v[180:181], v[188:189]
    v_pk_mul_f32 v[38:39], v[182:183], v[190:191]
    v_pk_add_f32 v[24:25], v[24:25], 1.0 op_sel_hi:[1,0]
    v_pk_add_f32 v[28:29], v[28:29], 1.0 op_sel_hi:[1,0]
    v_pk_add_f32 v[32:33], v[32:33], 1.0 op_sel_hi:[1,0]
    v_pk_add_f32 v[36:37], v[36:37], 1.0 op_sel_hi:[1,0]
    v_rcp_f32 v24, v24
    v_rcp_f32 v25, v25
    v_rcp_f32 v28, v28
    v_rcp_f32 v29, v29
    v_rcp_f32 v32, v32
    v_rcp_f32 v33, v33
    v_rcp_f32 v36, v36
    v_rcp_f32 v37, v37
    v_pk_mul_f32 v[176:177], v[26:27], v[24:25]
    v_pk_mul_f32 v[178:179], v[30:31], v[28:29]
    v_pk_mul_f32 v[180:181], v[34:35], v[32:33]
    v_pk_mul_f32 v[182:183], v[38:39], v[36:37]
    v_cvt_pk_bf16_f32 v48, v176, v177
    v_cvt_pk_bf16_f32 v49, v178, v179
    v_cvt_pk_bf16_f32 v50, v180, v181
    v_cvt_pk_bf16_f32 v51, v182, v183
    s_add_u32 s34, s33, 296960
    buffer_store_dwordx4 v[48:51], v14, s[8:11], s34 offen sc1
    v_pk_mul_f32 v[24:25], v[192:193], v[192:193]
    v_pk_mul_f32 v[28:29], v[194:195], v[194:195]
    v_pk_mul_f32 v[32:33], v[196:197], v[196:197]
    v_pk_mul_f32 v[36:37], v[198:199], v[198:199]
    v_pk_fma_f32 v[24:25], v[24:25], s[46:47], v[52:53] op_sel_hi:[1,0,0]
    v_pk_fma_f32 v[28:29], v[28:29], s[46:47], v[52:53] op_sel_hi:[1,0,0]
    v_pk_fma_f32 v[32:33], v[32:33], s[46:47], v[52:53] op_sel_hi:[1,0,0]
    v_pk_fma_f32 v[36:37], v[36:37], s[46:47], v[52:53] op_sel_hi:[1,0,0]
    v_pk_mul_f32 v[24:25], v[24:25], v[192:193]
    v_pk_mul_f32 v[28:29], v[28:29], v[194:195]
    v_pk_mul_f32 v[32:33], v[32:33], v[196:197]
    v_pk_mul_f32 v[36:37], v[36:37], v[198:199]
    v_exp_f32 v24, v24
    v_exp_f32 v25, v25
    v_exp_f32 v28, v28
    v_exp_f32 v29, v29
    v_exp_f32 v32, v32
    v_exp_f32 v33, v33
    v_exp_f32 v36, v36
    v_exp_f32 v37, v37
    v_pk_mul_f32 v[26:27], v[192:193], v[200:201]
    v_pk_mul_f32 v[30:31], v[194:195], v[202:203]
    v_pk_mul_f32 v[34:35], v[196:197], v[204:205]
    v_pk_mul_f32 v[38:39], v[198:199], v[206:207]
    v_pk_add_f32 v[24:25], v[24:25], 1.0 op_sel_hi:[1,0]
    v_pk_add_f32 v[28:29], v[28:29], 1.0 op_sel_hi:[1,0]
    v_pk_add_f32 v[32:33], v[32:33], 1.0 op_sel_hi:[1,0]
    v_pk_add_f32 v[36:37], v[36:37], 1.0 op_sel_hi:[1,0]
    v_rcp_f32 v24, v24
    v_rcp_f32 v25, v25
    v_rcp_f32 v28, v28
    v_rcp_f32 v29, v29
    v_rcp_f32 v32, v32
    v_rcp_f32 v33, v33
    v_rcp_f32 v36, v36
    v_rcp_f32 v37, v37
    v_pk_mul_f32 v[192:193], v[26:27], v[24:25]
    v_pk_mul_f32 v[194:195], v[30:31], v[28:29]
    v_pk_mul_f32 v[196:197], v[34:35], v[32:33]
    v_pk_mul_f32 v[198:199], v[38:39], v[36:37]
    v_cvt_pk_bf16_f32 v44, v192, v193
    v_cvt_pk_bf16_f32 v45, v194, v195
    v_cvt_pk_bf16_f32 v46, v196, v197
    v_cvt_pk_bf16_f32 v47, v198, v199
    s_add_u32 s34, s33, 3072
    buffer_store_dwordx4 v[44:47], v14, s[8:11], s34 offen sc1
    v_pk_mul_f32 v[24:25], v[208:209], v[208:209]
    v_pk_mul_f32 v[28:29], v[210:211], v[210:211]
    v_pk_mul_f32 v[32:33], v[212:213], v[212:213]
    v_pk_mul_f32 v[36:37], v[214:215], v[214:215]
    v_pk_fma_f32 v[24:25], v[24:25], s[46:47], v[52:53] op_sel_hi:[1,0,0]
    v_pk_fma_f32 v[28:29], v[28:29], s[46:47], v[52:53] op_sel_hi:[1,0,0]
    v_pk_fma_f32 v[32:33], v[32:33], s[46:47], v[52:53] op_sel_hi:[1,0,0]
    v_pk_fma_f32 v[36:37], v[36:37], s[46:47], v[52:53] op_sel_hi:[1,0,0]
    v_pk_mul_f32 v[24:25], v[24:25], v[208:209]
    v_pk_mul_f32 v[28:29], v[28:29], v[210:211]
    v_pk_mul_f32 v[32:33], v[32:33], v[212:213]
    v_pk_mul_f32 v[36:37], v[36:37], v[214:215]
    v_exp_f32 v24, v24
    v_exp_f32 v25, v25
    v_exp_f32 v28, v28
    v_exp_f32 v29, v29
    v_exp_f32 v32, v32
    v_exp_f32 v33, v33
    v_exp_f32 v36, v36
    v_exp_f32 v37, v37
    v_pk_mul_f32 v[26:27], v[208:209], v[216:217]
    v_pk_mul_f32 v[30:31], v[210:211], v[218:219]
    v_pk_mul_f32 v[34:35], v[212:213], v[220:221]
    v_pk_mul_f32 v[38:39], v[214:215], v[222:223]
    v_pk_add_f32 v[24:25], v[24:25], 1.0 op_sel_hi:[1,0]
    v_pk_add_f32 v[28:29], v[28:29], 1.0 op_sel_hi:[1,0]
    v_pk_add_f32 v[32:33], v[32:33], 1.0 op_sel_hi:[1,0]
    v_pk_add_f32 v[36:37], v[36:37], 1.0 op_sel_hi:[1,0]
    v_rcp_f32 v24, v24
    v_rcp_f32 v25, v25
    v_rcp_f32 v28, v28
    v_rcp_f32 v29, v29
    v_rcp_f32 v32, v32
    v_rcp_f32 v33, v33
    v_rcp_f32 v36, v36
    v_rcp_f32 v37, v37
    v_pk_mul_f32 v[208:209], v[26:27], v[24:25]
    v_pk_mul_f32 v[210:211], v[30:31], v[28:29]
    v_pk_mul_f32 v[212:213], v[34:35], v[32:33]
    v_pk_mul_f32 v[214:215], v[38:39], v[36:37]
    v_cvt_pk_bf16_f32 v48, v208, v209
    v_cvt_pk_bf16_f32 v49, v210, v211
    v_cvt_pk_bf16_f32 v50, v212, v213
    v_cvt_pk_bf16_f32 v51, v214, v215
    s_add_u32 s34, s33, 297984
    buffer_store_dwordx4 v[48:51], v14, s[8:11], s34 offen sc1
    v_pk_mul_f32 v[24:25], v[224:225], v[224:225]
    v_pk_mul_f32 v[28:29], v[226:227], v[226:227]
    v_pk_mul_f32 v[32:33], v[228:229], v[228:229]
    v_pk_mul_f32 v[36:37], v[230:231], v[230:231]
    v_pk_fma_f32 v[24:25], v[24:25], s[46:47], v[52:53] op_sel_hi:[1,0,0]
    v_pk_fma_f32 v[28:29], v[28:29], s[46:47], v[52:53] op_sel_hi:[1,0,0]
    v_pk_fma_f32 v[32:33], v[32:33], s[46:47], v[52:53] op_sel_hi:[1,0,0]
    v_pk_fma_f32 v[36:37], v[36:37], s[46:47], v[52:53] op_sel_hi:[1,0,0]
    v_pk_mul_f32 v[24:25], v[24:25], v[224:225]
    v_pk_mul_f32 v[28:29], v[28:29], v[226:227]
    v_pk_mul_f32 v[32:33], v[32:33], v[228:229]
    v_pk_mul_f32 v[36:37], v[36:37], v[230:231]
    v_exp_f32 v24, v24
    v_exp_f32 v25, v25
    v_exp_f32 v28, v28
    v_exp_f32 v29, v29
    v_exp_f32 v32, v32
    v_exp_f32 v33, v33
    v_exp_f32 v36, v36
    v_exp_f32 v37, v37
    v_pk_mul_f32 v[26:27], v[224:225], v[232:233]
    v_pk_mul_f32 v[30:31], v[226:227], v[234:235]
    v_pk_mul_f32 v[34:35], v[228:229], v[236:237]
    v_pk_mul_f32 v[38:39], v[230:231], v[238:239]
    v_pk_add_f32 v[24:25], v[24:25], 1.0 op_sel_hi:[1,0]
    v_pk_add_f32 v[28:29], v[28:29], 1.0 op_sel_hi:[1,0]
    v_pk_add_f32 v[32:33], v[32:33], 1.0 op_sel_hi:[1,0]
    v_pk_add_f32 v[36:37], v[36:37], 1.0 op_sel_hi:[1,0]
    v_rcp_f32 v24, v24
    v_rcp_f32 v25, v25
    v_rcp_f32 v28, v28
    v_rcp_f32 v29, v29
    v_rcp_f32 v32, v32
    v_rcp_f32 v33, v33
    v_rcp_f32 v36, v36
    v_rcp_f32 v37, v37
    v_pk_mul_f32 v[224:225], v[26:27], v[24:25]
    v_pk_mul_f32 v[226:227], v[30:31], v[28:29]
    v_pk_mul_f32 v[228:229], v[34:35], v[32:33]
    v_pk_mul_f32 v[230:231], v[38:39], v[36:37]
    v_cvt_pk_bf16_f32 v44, v224, v225
    v_cvt_pk_bf16_f32 v45, v226, v227
    v_cvt_pk_bf16_f32 v46, v228, v229
    v_cvt_pk_bf16_f32 v47, v230, v231
    s_add_u32 s34, s33, 4096
    buffer_store_dwordx4 v[44:47], v14, s[8:11], s34 offen sc1
    v_pk_mul_f32 v[24:25], v[240:241], v[240:241]
    v_pk_mul_f32 v[28:29], v[242:243], v[242:243]
    v_pk_mul_f32 v[32:33], v[244:245], v[244:245]
    v_pk_mul_f32 v[36:37], v[246:247], v[246:247]
    v_pk_fma_f32 v[24:25], v[24:25], s[46:47], v[52:53] op_sel_hi:[1,0,0]
    v_pk_fma_f32 v[28:29], v[28:29], s[46:47], v[52:53] op_sel_hi:[1,0,0]
    v_pk_fma_f32 v[32:33], v[32:33], s[46:47], v[52:53] op_sel_hi:[1,0,0]
    v_pk_fma_f32 v[36:37], v[36:37], s[46:47], v[52:53] op_sel_hi:[1,0,0]
    v_pk_mul_f32 v[24:25], v[24:25], v[240:241]
    v_pk_mul_f32 v[28:29], v[28:29], v[242:243]
    v_pk_mul_f32 v[32:33], v[32:33], v[244:245]
    v_pk_mul_f32 v[36:37], v[36:37], v[246:247]
    v_exp_f32 v24, v24
    v_exp_f32 v25, v25
    v_exp_f32 v28, v28
    v_exp_f32 v29, v29
    v_exp_f32 v32, v32
    v_exp_f32 v33, v33
    v_exp_f32 v36, v36
    v_exp_f32 v37, v37
    v_pk_mul_f32 v[26:27], v[240:241], v[248:249]
    v_pk_mul_f32 v[30:31], v[242:243], v[250:251]
    v_pk_mul_f32 v[34:35], v[244:245], v[252:253]
    v_pk_mul_f32 v[38:39], v[246:247], v[254:255]
    v_pk_add_f32 v[24:25], v[24:25], 1.0 op_sel_hi:[1,0]
    v_pk_add_f32 v[28:29], v[28:29], 1.0 op_sel_hi:[1,0]
    v_pk_add_f32 v[32:33], v[32:33], 1.0 op_sel_hi:[1,0]
    v_pk_add_f32 v[36:37], v[36:37], 1.0 op_sel_hi:[1,0]
    v_rcp_f32 v24, v24
    v_rcp_f32 v25, v25
    v_rcp_f32 v28, v28
    v_rcp_f32 v29, v29
    v_rcp_f32 v32, v32
    v_rcp_f32 v33, v33
    v_rcp_f32 v36, v36
    v_rcp_f32 v37, v37
    v_pk_mul_f32 v[240:241], v[26:27], v[24:25]
    v_pk_mul_f32 v[242:243], v[30:31], v[28:29]
    v_pk_mul_f32 v[244:245], v[34:35], v[32:33]
    v_pk_mul_f32 v[246:247], v[38:39], v[36:37]
    v_cvt_pk_bf16_f32 v48, v240, v241
    v_cvt_pk_bf16_f32 v49, v242, v243
    v_cvt_pk_bf16_f32 v50, v244, v245
    v_cvt_pk_bf16_f32 v51, v246, v247
    s_add_u32 s34, s33, 299008
    buffer_store_dwordx4 v[48:51], v14, s[8:11], s34 offen sc1
    s_waitcnt vmcnt(0)
    s_endpgm
K1_B:
    s_lshr_b32 s34, s26, 1
    s_and_b32 s35, s26, 1
    s_cmp_eq_u32 s34, 1
    s_cselect_b32 s40, s16, s12
    s_cselect_b32 s41, s17, s13
    s_mov_b32 s42, s14
    s_mov_b32 s43, s15
    s_mul_i32 s33, s24, 288
    s_mul_i32 s38, s35, 288
    v_add_u32 v20, 0, v2
    v_add_u32 v20, s38, v20
    v_mul_u32_u24 v21, 3641, v20
    v_lshrrev_b32 v21, 16, v21
    v_mul_u32_u24 v22, 18, v21
    v_sub_u32 v22, v20, v22
    v_mul_u32_u24 v21, 9216, v21
    v_lshl_add_u32 v14, v22, 4, v21
    v_add_u32 v20, 64, v2
    v_add_u32 v20, s38, v20
    v_mul_u32_u24 v21, 3641, v20
    v_lshrrev_b32 v21, 16, v21
    v_mul_u32_u24 v22, 18, v21
    v_sub_u32 v22, v20, v22
    v_mul_u32_u24 v21, 9216, v21
    v_lshl_add_u32 v15, v22, 4, v21
    v_add_u32 v20, 128, v2
    v_add_u32 v20, s38, v20
    v_mul_u32_u24 v21, 3641, v20
    v_lshrrev_b32 v21, 16, v21
    v_mul_u32_u24 v22, 18, v21
    v_sub_u32 v22, v20, v22
    v_mul_u32_u24 v21, 9216, v21
    v_lshl_add_u32 v16, v22, 4, v21
    v_add_u32 v20, 192, v2
    v_add_u32 v20, s38, v20
    v_mul_u32_u24 v21, 3641, v20
    v_lshrrev_b32 v21, 16, v21
    v_mul_u32_u24 v22, 18, v21
    v_sub_u32 v22, v20, v22
    v_mul_u32_u24 v21, 9216, v21
    v_lshl_add_u32 v17, v22, 4, v21
    v_add_u32 v20, 256, v2
    v_add_u32 v20, s38, v20
    v_mul_u32_u24 v21, 3641, v20
    v_lshrrev_b32 v21, 16, v21
    v_mul_u32_u24 v22, 18, v21
    v_sub_u32 v22, v20, v22
    v_mul_u32_u24 v21, 9216, v21
    v_lshl_add_u32 v18, v22, 4, v21
    s_mul_i32 s35, s35, 4608
    s_mul_i32 s34, s34, 9344
    s_add_u32 s35, s35, s34
    s_add_u32 s35, s35, 16384
    s_add_u32 s36, s32, s35
    s_add_u32 m0, s36, 0
    s_nop 0
    buffer_load_dwordx4 v14, s[40:43], s33 offen lds
    s_add_u32 m0, s36, 1024
    s_nop 0
    buffer_load_dwordx4 v15, s[40:43], s33 offen lds
    s_add_u32 m0, s36, 2048
    s_nop 0
    buffer_load_dwordx4 v16, s[40:43], s33 offen lds
    s_add_u32 m0, s36, 3072
    s_nop 0
    buffer_load_dwordx4 v17, s[40:43], s33 offen lds
    s_add_u32 m0, s36, 4096
    s_mov_b32 exec_hi, 0
    buffer_load_dwordx4 v18, s[40:43], s33 offen lds
    s_mov_b32 exec_hi, -1
    s_add_u32 s33, s33, 294912
    s_add_u32 s32, s32, 35072
    s_cmp_eq_u32 s32, 140288
    s_cselect_b32 s32, 0, s32
    s_add_u32 s36, s32, s35
    s_add_u32 m0, s36, 0
    s_nop 0
    buffer_load_dwordx4 v14, s[40:43], s33 offen lds
    s_add_u32 m0, s36, 1024
    s_nop 0
    buffer_load_dwordx4 v15, s[40:43], s33 offen lds
    s_add_u32 m0, s36, 2048
    s_nop 0
    buffer_load_dwordx4 v16, s[40:43], s33 offen lds
    s_add_u32 m0, s36, 3072
    s_nop 0
    buffer_load_dwordx4 v17, s[40:43], s33 offen lds
    s_add_u32 m0, s36, 4096
    s_mov_b32 exec_hi, 0
    buffer_load_dwordx4 v18, s[40:43], s33 offen lds
    s_mov_b32 exec_hi, -1
    s_add_u32 s33, s33, 294912
    s_add_u32 s32, s32, 35072
    s_cmp_eq_u32 s32, 140288
    s_cselect_b32 s32, 0, s32
    s_add_u32 s36, s32, s35
    s_add_u32 m0, s36, 0
    s_nop 0
    buffer_load_dwordx4 v14, s[40:43], s33 offen lds
    s_add_u32 m0, s36, 1024
    s_nop 0
    buffer_load_dwordx4 v15, s[40:43], s33 offen lds
    s_add_u32 m0, s36, 2048
    s_nop 0
    buffer_load_dwordx4 v16, s[40:43], s33 offen lds
    s_add_u32 m0, s36, 3072
    s_nop 0
    buffer_load_dwordx4 v17, s[40:43], s33 offen lds
    s_add_u32 m0, s36, 4096
    s_mov_b32 exec_hi, 0
    buffer_load_dwordx4 v18, s[40:43], s33 offen lds
    s_mov_b32 exec_hi, -1
    s_add_u32 s33, s33, 294912
    s_add_u32 s32, s32, 35072
    s_cmp_eq_u32 s32, 140288
    s_cselect_b32 s32, 0, s32
    s_add_u32 s36, s32, s35
    s_add_u32 m0, s36, 0
    s_nop 0
    buffer_load_dwordx4 v14, s[40:43], s33 offen lds
    s_add_u32 m0, s36, 1024
    s_nop 0
    buffer_load_dwordx4 v15, s[40:43], s33 offen lds
    s_add_u32 m0, s36, 2048
    s_nop 0
    buffer_load_dwordx4 v16, s[40:43], s33 offen lds
    s_add_u32 m0, s36, 3072
    s_nop 0
    buffer_load_dwordx4 v17, s[40:43], s33 offen lds
    s_add_u32 m0, s36, 4096
    s_mov_b32 exec_hi, 0
    buffer_load_dwordx4 v18, s[40:43], s33 offen lds
    s_mov_b32 exec_hi, -1
    s_add_u32 s33, s33, 294912
    s_add_u32 s32, s32, 35072
    s_cmp_eq_u32 s32, 140288
    s_cselect_b32 s32, 0, s32
    v_mov_b32 v96, 0
    v_mov_b32 v97, 0
    v_mov_b32 v98, 0
    v_mov_b32 v99, 0
    v_mov_b32 v100, 0
    v_mov_b32 v101, 0
    v_mov_b32 v102, 0
    v_mov_b32 v103, 0
    v_mov_b32 v104, 0
    v_mov_b32 v105, 0
    v_mov_b32 v106, 0
    v_mov_b32 v107, 0
    v_mov_b32 v108, 0
    v_mov_b32 v109, 0
    v_mov_b32 v110, 0
    v_mov_b32 v111, 0
    v_mov_b32 v112, 0
    v_mov_b32 v113, 0
    v_mov_b32 v114, 0
    v_mov_b32 v115, 0
    v_mov_b32 v116, 0
    v_mov_b32 v117, 0
    v_mov_b32 v118, 0
    v_mov_b32 v119, 0
    v_mov_b32 v120, 0
    v_mov_b32 v121, 0
    v_mov_b32 v122, 0
    v_mov_b32 v123, 0
    v_mov_b32 v124, 0
    v_mov_b32 v125, 0
    v_mov_b32 v126, 0
    v_mov_b32 v127, 0
    v_mov_b32 v128, 0
    v_mov_b32 v129, 0
    v_mov_b32 v130, 0
    v_mov_b32 v131, 0
    v_mov_b32 v132, 0
    v_mov_b32 v133, 0
    v_mov_b32 v134, 0
    v_mov_b32 v135, 0
    v_mov_b32 v136, 0
    v_mov_b32 v137, 0
    v_mov_b32 v138, 0
    v_mov_b32 v139, 0
    v_mov_b32 v140, 0
    v_mov_b32 v141, 0
    v_mov_b32 v142, 0
    v_mov_b32 v143, 0
    v_mov_b32 v144, 0
    v_mov_b32 v145, 0
    v_mov_b32 v146, 0
    v_mov_b32 v147, 0
    v_mov_b32 v148, 0
    v_mov_b32 v149, 0
    v_mov_b32 v150, 0
    v_mov_b32 v151, 0
    v_mov_b32 v152, 0
    v_mov_b32 v153, 0
    v_mov_b32 v154, 0
    v_mov_b32 v155, 0
    v_mov_b32 v156, 0
    v_mov_b32 v157, 0
    v_mov_b32 v158, 0
    v_mov_b32 v159, 0
    v_mov_b32 v160, 0
    v_mov_b32 v161, 0
    v_mov_b32 v162, 0
    v_mov_b32 v163, 0
    v_mov_b32 v164, 0
    v_mov_b32 v165, 0
    v_mov_b32 v166, 0
    v_mov_b32 v167, 0
    v_mov_b32 v168, 0
    v_mov_b32 v169, 0
    v_mov_b32 v170, 0
    v_mov_b32 v171, 0
    v_mov_b32 v172, 0
    v_mov_b32 v173, 0
    v_mov_b32 v174, 0
    v_mov_b32 v175, 0
    v_mov_b32 v176, 0
    v_mov_b32 v177, 0
    v_mov_b32 v178, 0
    v_mov_b32 v179, 0
    v_mov_b32 v180, 0
    v_mov_b32 v181, 0
    v_mov_b32 v182, 0
    v_mov_b32 v183, 0
    v_mov_b32 v184, 0
    v_mov_b32 v185, 0
    v_mov_b32 v186, 0
    v_mov_b32 v187, 0
    v_mov_b32 v188, 0
    v_mov_b32 v189, 0
    v_mov_b32 v190, 0
    v_mov_b32 v191, 0
    v_mov_b32 v192, 0
    v_mov_b32 v193, 0
    v_mov_b32 v194, 0
    v_mov_b32 v195, 0
    v_mov_b32 v196, 0
    v_mov_b32 v197, 0
    v_mov_b32 v198, 0
    v_mov_b32 v199, 0
    v_mov_b32 v200, 0
    v_mov_b32 v201, 0
    v_mov_b32 v202, 0
    v_mov_b32 v203, 0
    v_mov_b32 v204, 0
    v_mov_b32 v205, 0
    v_mov_b32 v206, 0
    v_mov_b32 v207, 0
    v_mov_b32 v208, 0
    v_mov_b32 v209, 0
    v_mov_b32 v210, 0
    v_mov_b32 v211, 0
    v_mov_b32 v212, 0
    v_mov_b32 v213, 0
    v_mov_b32 v214, 0
    v_mov_b32 v215, 0
    v_mov_b32 v216, 0
    v_mov_b32 v217, 0
    v_mov_b32 v218, 0
    v_mov_b32 v219, 0
    v_mov_b32 v220, 0
    v_mov_b32 v221, 0
    v_mov_b32 v222, 0
    v_mov_b32 v223, 0
    s_waitcnt vmcnt(15)
    s_barrier
    ds_read_b128 v[24:27], v12 offset:0
    ds_read_b128 v[28:31], v12 offset:2048
    ds_read_b64_tr_b16 v[40:41], v10 offset:0
    ds_read_b64_tr_b16 v[42:43], v10 offset:1152
    ds_read_b64_tr_b16 v[44:45], v10 offset:32
    ds_read_b64_tr_b16 v[46:47], v10 offset:1184
    ds_read_b64_tr_b16 v[48:49], v10 offset:64
    ds_read_b64_tr_b16 v[50:51], v10 offset:1216
    ds_read_b64_tr_b16 v[52:53], v10 offset:96
    ds_read_b64_tr_b16 v[54:55], v10 offset:1248
    s_mov_b32 s31, 0
K1B_LOOP:
    s_waitcnt lgkmcnt(0)
    v_mfma_f32_32x32x16_bf16 v[96:111], v[40:43], v[24:27], v[96:111]
    ds_read_b128 v[32:35], v12 offset:1024
    ds_read_b128 v[36:39], v12 offset:3072
    v_mfma_f32_32x32x16_bf16 v[112:127], v[40:43], v[28:31], v[112:127]
    ds_read_b64_tr_b16 v[56:57], v10 offset:4608
    v_mfma_f32_32x32x16_bf16 v[128:143], v[44:47], v[24:27], v[128:143]
    ds_read_b64_tr_b16 v[58:59], v10 offset:5760
    v_mfma_f32_32x32x16_bf16 v[144:159], v[44:47], v[28:31], v[144:159]
    ds_read_b64_tr_b16 v[60:61], v10 offset:4640
    v_mfma_f32_32x32x16_bf16 v[160:175], v[48:51], v[24:27], v[160:175]
    ds_read_b64_tr_b16 v[62:63], v10 offset:5792
    ds_read_b64_tr_b16 v[64:65], v10 offset:4672
    v_mfma_f32_32x32x16_bf16 v[176:191], v[48:51], v[28:31], v[176:191]
    ds_read_b64_tr_b16 v[66:67], v10 offset:5824
    v_mfma_f32_32x32x16_bf16 v[192:207], v[52:55], v[24:27], v[192:207]
    ds_read_b64_tr_b16 v[68:69], v10 offset:4704
    v_mfma_f32_32x32x16_bf16 v[208:223], v[52:55], v[28:31], v[208:223]
    ds_read_b64_tr_b16 v[70:71], v10 offset:5856
    s_add_u32 s30, s30, 35072
    s_cmp_eq_u32 s30, 140288
    s_cselect_b32 s30, 0, s30
    s_waitcnt vmcnt(10) lgkmcnt(0)
    s_barrier
    v_add_u32 v10, s30, v11
    v_add_u32 v12, s30, v13
    v_mfma_f32_32x32x16_bf16 v[96:111], v[56:59], v[32:35], v[96:111]
    ds_read_b128 v[24:27], v12 offset:0
    ds_read_b128 v[28:31], v12 offset:2048
    s_cmp_lt_u32 s31, 14
    s_cselect_b32 s10, 268435456, 0
    s_cselect_b32 s14, 5308416, 0
    s_cselect_b32 s18, 5308416, 0
    s_add_u32 s36, s32, s35
    v_mfma_f32_32x32x16_bf16 v[112:127], v[56:59], v[36:39], v[112:127]
    s_add_u32 m0, s36, 0
    s_nop 0
    buffer_load_dwordx4 v14, s[40:43], s33 offen lds
    s_add_u32 m0, s36, 1024
    v_mfma_f32_32x32x16_bf16 v[128:143], v[60:63], v[32:35], v[128:143]
    s_nop 0
    buffer_load_dwordx4 v15, s[40:43], s33 offen lds
    s_add_u32 m0, s36, 2048
    s_nop 0
    buffer_load_dwordx4 v16, s[40:43], s33 offen lds
    v_mfma_f32_32x32x16_bf16 v[144:159], v[60:63], v[36:39], v[144:159]
    s_add_u32 m0, s36, 3072
    s_nop 0
    buffer_load_dwordx4 v17, s[40:43], s33 offen lds
    s_add_u32 m0, s36, 4096
    v_mfma_f32_32x32x16_bf16 v[160:175], v[64:67], v[32:35], v[160:175]
    s_mov_b32 exec_hi, 0
    buffer_load_dwordx4 v18, s[40:43], s33 offen lds
    s_mov_b32 exec_hi, -1
    s_add_u32 s33, s33, 294912
    s_add_u32 s32, s32, 35072
    s_cmp_eq_u32 s32, 140288
    v_mfma_f32_32x32x16_bf16 v[176:191], v[64:67], v[36:39], v[176:191]
    s_cselect_b32 s32, 0, s32
    ds_read_b64_tr_b16 v[40:41], v10 offset:0
    ds_read_b64_tr_b16 v[42:43], v10 offset:1152
    v_mfma_f32_32x32x16_bf16 v[192:207], v[68:71], v[32:35], v[192:207]
    ds_read_b64_tr_b16 v[44:45], v10 offset:32
    ds_read_b64_tr_b16 v[46:47], v10 offset:1184
    ds_read_b64_tr_b16 v[48:49], v10 offset:64
    v_mfma_f32_32x32x16_bf16 v[208:223], v[68:71], v[36:39], v[208:223]
    ds_read_b64_tr_b16 v[50:51], v10 offset:1216
    ds_read_b64_tr_b16 v[52:53], v10 offset:96
    ds_read_b64_tr_b16 v[54:55], v10 offset:1248
    s_add_u32 s31, s31, 1
    s_cmp_lt_u32 s31, 18
    s_cbranch_scc1 K1B_LOOP
    s_mov_b32 s10, 268435456
    s_mov_b32 s14, 5308416
    s_mov_b32 s18, 5308416
    s_waitcnt lgkmcnt(0)
    s_lshl_b32 s33, s25, 3
    s_lshl_b32 s34, s26, 1
    s_add_u32 s33, s33, s34
    s_mul_i32 s33, s33, 288
    s_mul_i32 s34, s24, 9
    s_add_u32 s33, s33, s34
    s_add_u32 s33, s33, 5
    s_lshl_b32 s33, s33, 10
    s_add_u32 s33, s33, 16777216
    v_lshlrev_b32 v14, 4, v2
    v_mov_b32 v52, s47
    s_nop 7
    v_pk_mul_f32 v[24:25], v[96:97], v[96:97]
    v_pk_mul_f32 v[28:29], v[98:99], v[98:99]
    v_pk_mul_f32 v[32:33], v[100:101], v[100:101]
    v_pk_mul_f32 v[36:37], v[102:103], v[102:103]
    v_pk_fma_f32 v[24:25], v[24:25], s[46:47], v[52:53] op_sel_hi:[1,0,0]
    v_pk_fma_f32 v[28:29], v[28:29], s[46:47], v[52:53] op_sel_hi:[1,0,0]
    v_pk_fma_f32 v[32:33], v[32:33], s[46:47], v[52:53] op_sel_hi:[1,0,0]
    v_pk_fma_f32 v[36:37], v[36:37], s[46:47], v[52:53] op_sel_hi:[1,0,0]
    v_pk_mul_f32 v[24:25], v[24:25], v[96:97]
    v_pk_mul_f32 v[28:29], v[28:29], v[98:99]
    v_pk_mul_f32 v[32:33], v[32:33], v[100:101]
    v_pk_mul_f32 v[36:37], v[36:37], v[102:103]
    v_exp_f32 v24, v24
    v_exp_f32 v25, v25
    v_exp_f32 v28, v28
    v_exp_f32 v29, v29
    v_exp_f32 v32, v32
    v_exp_f32 v33, v33
    v_exp_f32 v36, v36
    v_exp_f32 v37, v37
    v_pk_mul_f32 v[26:27], v[96:97], v[104:105]
    v_pk_mul_f32 v[30:31], v[98:99], v[106:107]
    v_pk_mul_f32 v[34:35], v[100:101], v[108:109]
    v_pk_mul_f32 v[38:39], v[102:103], v[110:111]
    v_pk_add_f32 v[24:25], v[24:25], 1.0 op_sel_hi:[1,0]
    v_pk_add_f32 v[28:29], v[28:29], 1.0 op_sel_hi:[1,0]
    v_pk_add_f32 v[32:33], v[32:33], 1.0 op_sel_hi:[1,0]
    v_pk_add_f32 v[36:37], v[36:37], 1.0 op_sel_hi:[1,0]
    v_rcp_f32 v24, v24
    v_rcp_f32 v25, v25
    v_rcp_f32 v28, v28
    v_rcp_f32 v29, v29
    v_rcp_f32 v32, v32
    v_rcp_f32 v33, v33
    v_rcp_f32 v36, v36
    v_rcp_f32 v37, v37
    v_pk_mul_f32 v[96:97], v[26:27], v[24:25]
    v_pk_mul_f32 v[98:99], v[30:31], v[28:29]
    v_pk_mul_f32 v[100:101], v[34:35], v[32:33]
    v_pk_mul_f32 v[102:103], v[38:39], v[36:37]
    v_cvt_pk_bf16_f32 v44, v96, v97
    v_cvt_pk_bf16_f32 v45, v98, v99
    v_cvt_pk_bf16_f32 v46, v100, v101
    v_cvt_pk_bf16_f32 v47, v102, v103
    s_add_u32 s34, s33, 0
    buffer_store_dwordx4 v[44:47], v14, s[8:11], s34 offen sc1
    v_pk_mul_f32 v[24:25], v[112:113], v[112:113]
    v_pk_mul_f32 v[28:29], v[114:115], v[114:115]
    v_pk_mul_f32 v[32:33], v[116:117], v[116:117]
    v_pk_mul_f32 v[36:37], v[118:119], v[118:119]
    v_pk_fma_f32 v[24:25], v[24:25], s[46:47], v[52:53] op_sel_hi:[1,0,0]
    v_pk_fma_f32 v[28:29], v[28:29], s[46:47], v[52:53] op_sel_hi:[1,0,0]
    v_pk_fma_f32 v[32:33], v[32:33], s[46:47], v[52:53] op_sel_hi:[1,0,0]
    v_pk_fma_f32 v[36:37], v[36:37], s[46:47], v[52:53] op_sel_hi:[1,0,0]
    v_pk_mul_f32 v[24:25], v[24:25], v[112:113]
    v_pk_mul_f32 v[28:29], v[28:29], v[114:115]
    v_pk_mul_f32 v[32:33], v[32:33], v[116:117]
    v_pk_mul_f32 v[36:37], v[36:37], v[118:119]
    v_exp_f32 v24, v24
    v_exp_f32 v25, v25
    v_exp_f32 v28, v28
    v_exp_f32 v29, v29
    v_exp_f32 v32, v32
    v_exp_f32 v33, v33
    v_exp_f32 v36, v36
    v_exp_f32 v37, v37
    v_pk_mul_f32 v[26:27], v[112:113], v[120:121]
    v_pk_mul_f32 v[30:31], v[114:115], v[122:123]
    v_pk_mul_f32 v[34:35], v[116:117], v[124:125]
    v_pk_mul_f32 v[38:39], v[118:119], v[126:127]
    v_pk_add_f32 v[24:25], v[24:25], 1.0 op_sel_hi:[1,0]
    v_pk_add_f32 v[28:29], v[28:29], 1.0 op_sel_hi:[1,0]
    v_pk_add_f32 v[32:33], v[32:33], 1.0 op_sel_hi:[1,0]
    v_pk_add_f32 v[36:37], v[36:37], 1.0 op_sel_hi:[1,0]
    v_rcp_f32 v24, v24
    v_rcp_f32 v25, v25
    v_rcp_f32 v28, v28
    v_rcp_f32 v29, v29
    v_rcp_f32 v32, v32
    v_rcp_f32 v33, v33
    v_rcp_f32 v36, v36
    v_rcp_f32 v37, v37
    v_pk_mul_f32 v[112:113], v[26:27], v[24:25]
    v_pk_mul_f32 v[114:115], v[30:31], v[28:29]
    v_pk_mul_f32 v[116:117], v[34:35], v[32:33]
    v_pk_mul_f32 v[118:119], v[38:39], v[36:37]
    v_cvt_pk_bf16_f32 v48, v112, v113
    v_cvt_pk_bf16_f32 v49, v114, v115
    v_cvt_pk_bf16_f32 v50, v116, v117
    v_cvt_pk_bf16_f32 v51, v118, v119
    s_add_u32 s34, s33, 294912
    buffer_store_dwordx4 v[48:51], v14, s[8:11], s34 offen sc1
    v_pk_mul_f32 v[24:25], v[128:129], v[128:129]
    v_pk_mul_f32 v[28:29], v[130:131], v[130:131]
    v_pk_mul_f32 v[32:33], v[132:133], v[132:133]
    v_pk_mul_f32 v[36:37], v[134:135], v[134:135]
    v_pk_fma_f32 v[24:25], v[24:25], s[46:47], v[52:53] op_sel_hi:[1,0,0]
    v_pk_fma_f32 v[28:29], v[28:29], s[46:47], v[52:53] op_sel_hi:[1,0,0]
    v_pk_fma_f32 v[32:33], v[32:33], s[46:47], v[52:53] op_sel_hi:[1,0,0]
    v_pk_fma_f32 v[36:37], v[36:37], s[46:47], v[52:53] op_sel_hi:[1,0,0]
    v_pk_mul_f32 v[24:25], v[24:25], v[128:129]
    v_pk_mul_f32 v[28:29], v[28:29], v[130:131]
    v_pk_mul_f32 v[32:33], v[32:33], v[132:133]
    v_pk_mul_f32 v[36:37], v[36:37], v[134:135]
    v_exp_f32 v24, v24
    v_exp_f32 v25, v25
    v_exp_f32 v28, v28
    v_exp_f32 v29, v29
    v_exp_f32 v32, v32
    v_exp_f32 v33, v33
    v_exp_f32 v36, v36
    v_exp_f32 v37, v37
    v_pk_mul_f32 v[26:27], v[128:129], v[136:137]
    v_pk_mul_f32 v[30:31], v[130:131], v[138:139]
    v_pk_mul_f32 v[34:35], v[132:133], v[140:141]
    v_pk_mul_f32 v[38:39], v[134:135], v[142:143]
    v_pk_add_f32 v[24:25], v[24:25], 1.0 op_sel_hi:[1,0]
    v_pk_add_f32 v[28:29], v[28:29], 1.0 op_sel_hi:[1,0]
    v_pk_add_f32 v[32:33], v[32:33], 1.0 op_sel_hi:[1,0]
    v_pk_add_f32 v[36:37], v[36:37], 1.0 op_sel_hi:[1,0]
    v_rcp_f32 v24, v24
    v_rcp_f32 v25, v25
    v_rcp_f32 v28, v28
    v_rcp_f32 v29, v29
    v_rcp_f32 v32, v32
    v_rcp_f32 v33, v33
    v_rcp_f32 v36, v36
    v_rcp_f32 v37, v37
    v_pk_mul_f32 v[128:129], v[26:27], v[24:25]
    v_pk_mul_f32 v[130:131], v[30:31], v[28:29]
    v_pk_mul_f32 v[132:133], v[34:35], v[32:33]
    v_pk_mul_f32 v[134:135], v[38:39], v[36:37]
    v_cvt_pk_bf16_f32 v44, v128, v129
    v_cvt_pk_bf16_f32 v45, v130, v131
    v_cvt_pk_bf16_f32 v46, v132, v133
    v_cvt_pk_bf16_f32 v47, v134, v135
    s_add_u32 s34, s33, 1024
    buffer_store_dwordx4 v[44:47], v14, s[8:11], s34 offen sc1
    v_pk_mul_f32 v[24:25], v[144:145], v[144:145]
    v_pk_mul_f32 v[28:29], v[146:147], v[146:147]
    v_pk_mul_f32 v[32:33], v[148:149], v[148:149]
    v_pk_mul_f32 v[36:37], v[150:151], v[150:151]
    v_pk_fma_f32 v[24:25], v[24:25], s[46:47], v[52:53] op_sel_hi:[1,0,0]
    v_pk_fma_f32 v[28:29], v[28:29], s[46:47], v[52:53] op_sel_hi:[1,0,0]
    v_pk_fma_f32 v[32:33], v[32:33], s[46:47], v[52:53] op_sel_hi:[1,0,0]
    v_pk_fma_f32 v[36:37], v[36:37], s[46:47], v[52:53] op_sel_hi:[1,0,0]
    v_pk_mul_f32 v[24:25], v[24:25], v[144:145]
    v_pk_mul_f32 v[28:29], v[28:29], v[146:147]
    v_pk_mul_f32 v[32:33], v[32:33], v[148:149]
    v_pk_mul_f32 v[36:37], v[36:37], v[150:151]
    v_exp_f32 v24, v24
    v_exp_f32 v25, v25
    v_exp_f32 v28, v28
    v_exp_f32 v29, v29
    v_exp_f32 v32, v32
    v_exp_f32 v33, v33
    v_exp_f32 v36, v36
    v_exp_f32 v37, v37
    v_pk_mul_f32 v[26:27], v[144:145], v[152:153]
    v_pk_mul_f32 v[30:31], v[146:147], v[154:155]
    v_pk_mul_f32 v[34:35], v[148:149], v[156:157]
    v_pk_mul_f32 v[38:39], v[150:151], v[158:159]
    v_pk_add_f32 v[24:25], v[24:25], 1.0 op_sel_hi:[1,0]
    v_pk_add_f32 v[28:29], v[28:29], 1.0 op_sel_hi:[1,0]
    v_pk_add_f32 v[32:33], v[32:33], 1.0 op_sel_hi:[1,0]
    v_pk_add_f32 v[36:37], v[36:37], 1.0 op_sel_hi:[1,0]
    v_rcp_f32 v24, v24
    v_rcp_f32 v25, v25
    v_rcp_f32 v28, v28
    v_rcp_f32 v29, v29
    v_rcp_f32 v32, v32
    v_rcp_f32 v33, v33
    v_rcp_f32 v36, v36
    v_rcp_f32 v37, v37
    v_pk_mul_f32 v[144:145], v[26:27], v[24:25]
    v_pk_mul_f32 v[146:147], v[30:31], v[28:29]
    v_pk_mul_f32 v[148:149], v[34:35], v[32:33]
    v_pk_mul_f32 v[150:151], v[38:39], v[36:37]
    v_cvt_pk_bf16_f32 v48, v144, v145
    v_cvt_pk_bf16_f32 v49, v146, v147
    v_cvt_pk_bf16_f32 v50, v148, v149
    v_cvt_pk_bf16_f32 v51, v150, v151
    s_add_u32 s34, s33, 295936
    buffer_store_dwordx4 v[48:51], v14, s[8:11], s34 offen sc1
    v_pk_mul_f32 v[24:25], v[160:161], v[160:161]
    v_pk_mul_f32 v[28:29], v[162:163], v[162:163]
    v_pk_mul_f32 v[32:33], v[164:165], v[164:165]
    v_pk_mul_f32 v[36:37], v[166:167], v[166:167]
    v_pk_fma_f32 v[24:25], v[24:25], s[46:47], v[52:53] op_sel_hi:[1,0,0]
    v_pk_fma_f32 v[28:29], v[28:29], s[46:47], v[52:53] op_sel_hi:[1,0,0]
    v_pk_fma_f32 v[32:33], v[32:33], s[46:47], v[52:53] op_sel_hi:[1,0,0]
    v_pk_fma_f32 v[36:37], v[36:37], s[46:47], v[52:53] op_sel_hi:[1,0,0]
    v_pk_mul_f32 v[24:25], v[24:25], v[160:161]
    v_pk_mul_f32 v[28:29], v[28:29], v[162:163]
    v_pk_mul_f32 v[32:33], v[32:33], v[164:165]
    v_pk_mul_f32 v[36:37], v[36:37], v[166:167]
    v_exp_f32 v24, v24
    v_exp_f32 v25, v25
    v_exp_f32 v28, v28
    v_exp_f32 v29, v29
    v_exp_f32 v32, v32
    v_exp_f32 v33, v33
    v_exp_f32 v36, v36
    v_exp_f32 v37, v37
    v_pk_mul_f32 v[26:27], v[160:161], v[168:169]
    v_pk_mul_f32 v[30:31], v[162:163], v[170:171]
    v_pk_mul_f32 v[34:35], v[164:165], v[172:173]
    v_pk_mul_f32 v[38:39], v[166:167], v[174:175]
    v_pk_add_f32 v[24:25], v[24:25], 1.0 op_sel_hi:[1,0]
    v_pk_add_f32 v[28:29], v[28:29], 1.0 op_sel_hi:[1,0]
    v_pk_add_f32 v[32:33], v[32:33], 1.0 op_sel_hi:[1,0]
    v_pk_add_f32 v[36:37], v[36:37], 1.0 op_sel_hi:[1,0]
    v_rcp_f32 v24, v24
    v_rcp_f32 v25, v25
    v_rcp_f32 v28, v28
    v_rcp_f32 v29, v29
    v_rcp_f32 v32, v32
    v_rcp_f32 v33, v33
    v_rcp_f32 v36, v36
    v_rcp_f32 v37, v37
    v_pk_mul_f32 v[160:161], v[26:27], v[24:25]
    v_pk_mul_f32 v[162:163], v[30:31], v[28:29]
    v_pk_mul_f32 v[164:165], v[34:35], v[32:33]
    v_pk_mul_f32 v[166:167], v[38:39], v[36:37]
    v_cvt_pk_bf16_f32 v44, v160, v161
    v_cvt_pk_bf16_f32 v45, v162, v163
    v_cvt_pk_bf16_f32 v46, v164, v165
    v_cvt_pk_bf16_f32 v47, v166, v167
    s_add_u32 s34, s33, 2048
    buffer_store_dwordx4 v[44:47], v14, s[8:11], s34 offen sc1
    v_pk_mul_f32 v[24:25], v[176:177], v[176:177]
    v_pk_mul_f32 v[28:29], v[178:179], v[178:179]
    v_pk_mul_f32 v[32:33], v[180:181], v[180:181]
    v_pk_mul_f32 v[36:37], v[182:183], v[182:183]
    v_pk_fma_f32 v[24:25], v[24:25], s[46:47], v[52:53] op_sel_hi:[1,0,0]
    v_pk_fma_f32 v[28:29], v[28:29], s[46:47], v[52:53] op_sel_hi:[1,0,0]
    v_pk_fma_f32 v[32:33], v[32:33], s[46:47], v[52:53] op_sel_hi:[1,0,0]
    v_pk_fma_f32 v[36:37], v[36:37], s[46:47], v[52:53] op_sel_hi:[1,0,0]
    v_pk_mul_f32 v[24:25], v[24:25], v[176:177]
    v_pk_mul_f32 v[28:29], v[28:29], v[178:179]
    v_pk_mul_f32 v[32:33], v[32:33], v[180:181]
    v_pk_mul_f32 v[36:37], v[36:37], v[182:183]
    v_exp_f32 v24, v24
    v_exp_f32 v25, v25
    v_exp_f32 v28, v28
    v_exp_f32 v29, v29
    v_exp_f32 v32, v32
    v_exp_f32 v33, v33
    v_exp_f32 v36, v36
    v_exp_f32 v37, v37
    v_pk_mul_f32 v[26:27], v[176:177], v[184:185]
    v_pk_mul_f32 v[30:31], v[178:179], v[186:187]
    v_pk_mul_f32 v[34:35], v[180:181], v[188:189]
    v_pk_mul_f32 v[38:39], v[182:183], v[190:191]
    v_pk_add_f32 v[24:25], v[24:25], 1.0 op_sel_hi:[1,0]
    v_pk_add_f32 v[28:29], v[28:29], 1.0 op_sel_hi:[1,0]
    v_pk_add_f32 v[32:33], v[32:33], 1.0 op_sel_hi:[1,0]
    v_pk_add_f32 v[36:37], v[36:37], 1.0 op_sel_hi:[1,0]
    v_rcp_f32 v24, v24
    v_rcp_f32 v25, v25
    v_rcp_f32 v28, v28
    v_rcp_f32 v29, v29
    v_rcp_f32 v32, v32
    v_rcp_f32 v33, v33
    v_rcp_f32 v36, v36
    v_rcp_f32 v37, v37
    v_pk_mul_f32 v[176:177], v[26:27], v[24:25]
    v_pk_mul_f32 v[178:179], v[30:31], v[28:29]
    v_pk_mul_f32 v[180:181], v[34:35], v[32:33]
    v_pk_mul_f32 v[182:183], v[38:39], v[36:37]
    v_cvt_pk_bf16_f32 v48, v176, v177
    v_cvt_pk_bf16_f32 v49, v178, v179
    v_cvt_pk_bf16_f32 v50, v180, v181
    v_cvt_pk_bf16_f32 v51, v182, v183
    s_add_u32 s34, s33, 296960
    buffer_store_dwordx4 v[48:51], v14, s[8:11], s34 offen sc1
    v_pk_mul_f32 v[24:25], v[192:193], v[192:193]
    v_pk_mul_f32 v[28:29], v[194:195], v[194:195]
    v_pk_mul_f32 v[32:33], v[196:197], v[196:197]
    v_pk_mul_f32 v[36:37], v[198:199], v[198:199]
    v_pk_fma_f32 v[24:25], v[24:25], s[46:47], v[52:53] op_sel_hi:[1,0,0]
    v_pk_fma_f32 v[28:29], v[28:29], s[46:47], v[52:53] op_sel_hi:[1,0,0]
    v_pk_fma_f32 v[32:33], v[32:33], s[46:47], v[52:53] op_sel_hi:[1,0,0]
    v_pk_fma_f32 v[36:37], v[36:37], s[46:47], v[52:53] op_sel_hi:[1,0,0]
    v_pk_mul_f32 v[24:25], v[24:25], v[192:193]
    v_pk_mul_f32 v[28:29], v[28:29], v[194:195]
    v_pk_mul_f32 v[32:33], v[32:33], v[196:197]
    v_pk_mul_f32 v[36:37], v[36:37], v[198:199]
    v_exp_f32 v24, v24
    v_exp_f32 v25, v25
    v_exp_f32 v28, v28
    v_exp_f32 v29, v29
    v_exp_f32 v32, v32
    v_exp_f32 v33, v33
    v_exp_f32 v36, v36
    v_exp_f32 v37, v37
    v_pk_mul_f32 v[26:27], v[192:193], v[200:201]
    v_pk_mul_f32 v[30:31], v[194:195], v[202:203]
    v_pk_mul_f32 v[34:35], v[196:197], v[204:205]
    v_pk_mul_f32 v[38:39], v[198:199], v[206:207]
    v_pk_add_f32 v[24:25], v[24:25], 1.0 op_sel_hi:[1,0]
    v_pk_add_f32 v[28:29], v[28:29], 1.0 op_sel_hi:[1,0]
    v_pk_add_f32 v[32:33], v[32:33], 1.0 op_sel_hi:[1,0]
    v_pk_add_f32 v[36:37], v[36:37], 1.0 op_sel_hi:[1,0]
    v_rcp_f32 v24, v24
    v_rcp_f32 v25, v25
    v_rcp_f32 v28, v28
    v_rcp_f32 v29, v29
    v_rcp_f32 v32, v32
    v_rcp_f32 v33, v33
    v_rcp_f32 v36, v36
    v_rcp_f32 v37, v37
    v_pk_mul_f32 v[192:193], v[26:27], v[24:25]
    v_pk_mul_f32 v[194:195], v[30:31], v[28:29]
    v_pk_mul_f32 v[196:197], v[34:35], v[32:33]
    v_pk_mul_f32 v[198:199], v[38:39], v[36:37]
    v_cvt_pk_bf16_f32 v44, v192, v193
    v_cvt_pk_bf16_f32 v45, v194, v195
    v_cvt_pk_bf16_f32 v46, v196, v197
    v_cvt_pk_bf16_f32 v47, v198, v199
    s_add_u32 s34, s33, 3072
    buffer_store_dwordx4 v[44:47], v14, s[8:11], s34 offen sc1
    v_pk_mul_f32 v[24:25], v[208:209], v[208:209]
    v_pk_mul_f32 v[28:29], v[210:211], v[210:211]
    v_pk_mul_f32 v[32:33], v[212:213], v[212:213]
    v_pk_mul_f32 v[36:37], v[214:215], v[214:215]
    v_pk_fma_f32 v[24:25], v[24:25], s[46:47], v[52:53] op_sel_hi:[1,0,0]
    v_pk_fma_f32 v[28:29], v[28:29], s[46:47], v[52:53] op_sel_hi:[1,0,0]
    v_pk_fma_f32 v[32:33], v[32:33], s[46:47], v[52:53] op_sel_hi:[1,0,0]
    v_pk_fma_f32 v[36:37], v[36:37], s[46:47], v[52:53] op_sel_hi:[1,0,0]
    v_pk_mul_f32 v[24:25], v[24:25], v[208:209]
    v_pk_mul_f32 v[28:29], v[28:29], v[210:211]
    v_pk_mul_f32 v[32:33], v[32:33], v[212:213]
    v_pk_mul_f32 v[36:37], v[36:37], v[214:215]
    v_exp_f32 v24, v24
    v_exp_f32 v25, v25
    v_exp_f32 v28, v28
    v_exp_f32 v29, v29
    v_exp_f32 v32, v32
    v_exp_f32 v33, v33
    v_exp_f32 v36, v36
    v_exp_f32 v37, v37
    v_pk_mul_f32 v[26:27], v[208:209], v[216:217]
    v_pk_mul_f32 v[30:31], v[210:211], v[218:219]
    v_pk_mul_f32 v[34:35], v[212:213], v[220:221]
    v_pk_mul_f32 v[38:39], v[214:215], v[222:223]
    v_pk_add_f32 v[24:25], v[24:25], 1.0 op_sel_hi:[1,0]
    v_pk_add_f32 v[28:29], v[28:29], 1.0 op_sel_hi:[1,0]
    v_pk_add_f32 v[32:33], v[32:33], 1.0 op_sel_hi:[1,0]
    v_pk_add_f32 v[36:37], v[36:37], 1.0 op_sel_hi:[1,0]
    v_rcp_f32 v24, v24
    v_rcp_f32 v25, v25
    v_rcp_f32 v28, v28
    v_rcp_f32 v29, v29
    v_rcp_f32 v32, v32
    v_rcp_f32 v33, v33
    v_rcp_f32 v36, v36
    v_rcp_f32 v37, v37
    v_pk_mul_f32 v[208:209], v[26:27], v[24:25]
    v_pk_mul_f32 v[210:211], v[30:31], v[28:29]
    v_pk_mul_f32 v[212:213], v[34:35], v[32:33]
    v_pk_mul_f32 v[214:215], v[38:39], v[36:37]
    v_cvt_pk_bf16_f32 v48, v208, v209
    v_cvt_pk_bf16_f32 v49, v210, v211
    v_cvt_pk_bf16_f32 v50, v212, v213
    v_cvt_pk_bf16_f32 v51, v214, v215
    s_add_u32 s34, s33, 297984
    buffer_store_dwordx4 v[48:51], v14, s[8:11], s34 offen sc1
    s_waitcnt vmcnt(0)
    s_endpgm
K1_END:
    s_endpgm
.globl k2_kernel
.p2align 8
.type k2_kernel,@function
k2_kernel:
    s_cmp_ge_u32 s2, 330
    s_cbranch_scc1 K2_END
    s_load_dwordx2 s[6:7], s[0:1], 72
    s_load_dwordx2 s[20:21], s[0:1], 48
    v_lshrrev_b32 v1, 6, v0
    v_and_b32 v2, 63, v0
    s_nop 0
    v_readfirstlane_b32 s3, v1
    s_waitcnt lgkmcnt(0)
    s_mov_b32 s8, s6
    s_mov_b32 s9, s7
    s_mov_b32 s10, 268435456
    s_mov_b32 s11, 0x00020000
    s_mov_b32 s12, s20
    s_mov_b32 s13, s21
    s_mov_b32 s14, 5308416
    s_mov_b32 s15, 0x00020000
    s_cmp_lt_u32 s2, 74
    s_cbranch_scc1 K2_FFT
    s_sub_u32 s2, s2, 74
    s_and_b32 s24, s2, 7
    s_lshr_b32 s25, s2, 4
    s_bfe_u32 s28, s2, 0x10003
    v_bfe_u32 v8, v2, 4, 1
    v_lshrrev_b32 v9, 5, v2
    v_bfe_u32 v5, v2, 2, 2
    v_and_b32 v10, 1, v2
    v_bfe_u32 v11, v2, 1, 1
    v_lshlrev_b32 v10, 4, v10
    v_lshl_or_b32 v10, v11, 3, v10
    v_lshl_add_u32 v5, v9, 3, v5
    v_mul_u32_u24 v5, 576, v5
    v_add_u32 v5, v5, v10
    v_lshl_add_u32 v5, v8, 5, v5
    v_add_u32 v5, 8192, v5
    s_and_b32 s26, s3, 3
    s_lshr_b32 s27, s3, 2
    s_mul_i32 s29, s27, 320
    v_add_u32 v5, s29, v5
    v_mov_b32 v4, v5
    v_lshlrev_b32 v7, 4, v2
    s_lshl_b32 s29, s26, 11
    v_add_u32 v7, s29, v7
    v_mov_b32 v6, v7
    s_mov_b32 s30, 0
    s_mov_b32 s32, 0
    s_mul_i32 s38, s24, 663552
    s_mul_i32 s39, s28, 576
    s_add_u32 s38, s38, s39
    s_cmp_eq_u32 s27, 1
    s_cbranch_scc1 K2_B
    s_lshl_b32 s33, s25, 2
    s_add_u32 s33, s33, s26
    s_mul_i32 s33, s33, 288
    s_mul_i32 s34, s24, 36
    s_add_u32 s33, s33, s34
    s_lshl_b32 s33, s33, 10
    s_add_u32 s33, s33, 16777216
    v_lshlrev_b32 v1, 4, v2
    s_lshl_b32 s35, s26, 11
    s_lshl_b32 s39, s26, 6
    s_lshl_b32 s34, s26, 10
    s_add_u32 s34, s34, 8192
    v_add_u32 v20, 0, v2
    v_add_u32 v20, s39, v20
    v_mul_u32_u24 v21, 1821, v20
    v_lshrrev_b32 v21, 16, v21
    v_mul_u32_u24 v22, 36, v21
    v_sub_u32 v22, v20, v22
    v_mul_u32_u24 v21, 1152, v21
    v_lshl_add_u32 v3, v22, 4, v21
    s_add_u32 m0, s32, s35
    s_add_u32 s37, s33, 1024
    buffer_load_dwordx4 v1, s[8:11], s33 offen lds
    s_add_u32 m0, m0, 1024
    s_add_u32 s33, s33, 2048
    buffer_load_dwordx4 v1, s[8:11], s37 offen lds
    s_add_u32 m0, s32, s34
    s_nop 0
    buffer_load_dwordx4 v3, s[12:15], s38 offen lds
    s_add_u32 s38, s38, 36864
    s_add_u32 s32, s32, 26624
    s_cmp_eq_u32 s32, 79872
    s_cselect_b32 s32, 0, s32
    s_add_u32 m0, s32, s35
    s_add_u32 s37, s33, 1024
    buffer_load_dwordx4 v1, s[8:11], s33 offen lds
    s_add_u32 m0, m0, 1024
    s_add_u32 s33, s33, 2048
    buffer_load_dwordx4 v1, s[8:11], s37 offen lds
    s_add_u32 m0, s32, s34
    s_nop 0
    buffer_load_dwordx4 v3, s[12:15], s38 offen lds
    s_add_u32 s38, s38, 36864
    s_add_u32 s32, s32, 26624
    s_cmp_eq_u32 s32, 79872
    s_cselect_b32 s32, 0, s32
    s_add_u32 m0, s32, s35
    s_add_u32 s37, s33, 1024
    buffer_load_dwordx4 v1, s[8:11], s33 offen lds
    s_add_u32 m0, m0, 1024
    s_add_u32 s33, s33, 2048
    buffer_load_dwordx4 v1, s[8:11], s37 offen lds
    s_add_u32 m0, s32, s34
    s_nop 0
    buffer_load_dwordx4 v3, s[12:15], s38 offen lds
    s_add_u32 s38, s38, 36864
    s_add_u32 s32, s32, 26624
    s_cmp_eq_u32 s32, 79872
    s_cselect_b32 s32, 0, s32
    v_mov_b32 v48, 0
    v_mov_b32 v49, 0
    v_mov_b32 v50, 0
    v_mov_b32 v51, 0
    v_mov_b32 v52, 0
    v_mov_b32 v53, 0
    v_mov_b32 v54, 0
    v_mov_b32 v55, 0
    v_mov_b32 v56, 0
    v_mov_b32 v57, 0
    v_mov_b32 v58, 0
    v_mov_b32 v59, 0
    v_mov_b32 v60, 0
    v_mov_b32 v61, 0
    v_mov_b32 v62, 0
    v_mov_b32 v63, 0
    v_mov_b32 v64, 0
    v_mov_b32 v65, 0
    v_mov_b32 v66, 0
    v_mov_b32 v67, 0
    v_mov_b32 v68, 0
    v_mov_b32 v69, 0
    v_mov_b32 v70, 0
    v_mov_b32 v71, 0
    v_mov_b32 v72, 0
    v_mov_b32 v73, 0
    v_mov_b32 v74, 0
    v_mov_b32 v75, 0
    v_mov_b32 v76, 0
    v_mov_b32 v77, 0
    v_mov_b32 v78, 0
    v_mov_b32 v79, 0
    v_mov_b32 v80, 0
    v_mov_b32 v81, 0
    v_mov_b32 v82, 0
    v_mov_b32 v83, 0
    v_mov_b32 v84, 0
    v_mov_b32 v85, 0
    v_mov_b32 v86, 0
    v_mov_b32 v87, 0
    v_mov_b32 v88, 0
    v_mov_b32 v89, 0
    v_mov_b32 v90, 0
    v_mov_b32 v91, 0
    v_mov_b32 v92, 0
    v_mov_b32 v93, 0
    v_mov_b32 v94, 0
    v_mov_b32 v95, 0
    v_mov_b32 v96, 0
    v_mov_b32 v97, 0
    v_mov_b32 v98, 0
    v_mov_b32 v99, 0
    v_mov_b32 v100, 0
    v_mov_b32 v101, 0
    v_mov_b32 v102, 0
    v_mov_b32 v103, 0
    v_mov_b32 v104, 0
    v_mov_b32 v105, 0
    v_mov_b32 v106, 0
    v_mov_b32 v107, 0
    v_mov_b32 v108, 0
    v_mov_b32 v109, 0
    v_mov_b32 v110, 0
    v_mov_b32 v111, 0
    v_mov_b32 v112, 0
    v_mov_b32 v113, 0
    v_mov_b32 v114, 0
    v_mov_b32 v115, 0
    v_mov_b32 v116, 0
    v_mov_b32 v117, 0
    v_mov_b32 v118, 0
    v_mov_b32 v119, 0
    v_mov_b32 v120, 0
    v_mov_b32 v121, 0
    v_mov_b32 v122, 0
    v_mov_b32 v123, 0
    v_mov_b32 v124, 0
    v_mov_b32 v125, 0
    v_mov_b32 v126, 0
    v_mov_b32 v127, 0
    s_waitcnt vmcnt(6)
    s_barrier
    ds_read_b128 v[8:11], v6 offset:0
    ds_read_b64_tr_b16 v[24:25], v4 offset:128
    ds_read_b64_tr_b16 v[26:27], v4 offset:2432
    ds_read_b64_tr_b16 v[28:29], v4 offset:192
    ds_read_b64_tr_b16 v[30:31], v4 offset:2496
    ds_read_b64_tr_b16 v[32:33], v4 offset:256
    ds_read_b64_tr_b16 v[34:35], v4 offset:2560
    ds_read_b64_tr_b16 v[16:17], v4 offset:0
    ds_read_b64_tr_b16 v[18:19], v4 offset:2304
    ds_read_b64_tr_b16 v[20:21], v4 offset:64
    ds_read_b64_tr_b16 v[22:23], v4 offset:2368
    s_mov_b32 s31, 0
K2A_LOOP:
    s_waitcnt lgkmcnt(0)
    v_mfma_f32_32x32x16_bf16 v[48:63], v[16:19], v[8:11], v[48:63]
    ds_read_b128 v[12:15], v6 offset:1024
    ds_read_b64_tr_b16 v[36:37], v4 offset:9344
    ds_read_b64_tr_b16 v[38:39], v4 offset:11648
    v_mfma_f32_32x32x16_bf16 v[64:79], v[20:23], v[8:11], v[64:79]
    ds_read_b64_tr_b16 v[40:41], v4 offset:9408
    ds_read_b64_tr_b16 v[42:43], v4 offset:11712
    v_mfma_f32_32x32x16_bf16 v[80:95], v[24:27], v[8:11], v[80:95]
    ds_read_b64_tr_b16 v[44:45], v4 offset:9472
    ds_read_b64_tr_b16 v[46:47], v4 offset:11776
    v_mfma_f32_32x32x16_bf16 v[96:111], v[28:31], v[8:11], v[96:111]
    ds_read_b64_tr_b16 v[16:17], v4 offset:9216
    ds_read_b64_tr_b16 v[18:19], v4 offset:11520
    v_mfma_f32_32x32x16_bf16 v[112:127], v[32:35], v[8:11], v[112:127]
    ds_read_b64_tr_b16 v[20:21], v4 offset:9280
    ds_read_b64_tr_b16 v[22:23], v4 offset:11584
    s_add_u32 s30, s30, 26624
    s_cmp_eq_u32 s30, 79872
    s_cselect_b32 s30, 0, s30
    s_waitcnt vmcnt(3) lgkmcnt(0)
    s_barrier
    v_add_u32 v4, s30, v5
    v_add_u32 v6, s30, v7
    v_mfma_f32_32x32x16_bf16 v[48:63], v[16:19], v[12:15], v[48:63]
    ds_read_b128 v[8:11], v6 offset:0
    ds_read_b64_tr_b16 v[24:25], v4 offset:128
    s_cmp_lt_u32 s31, 15
    s_cselect_b32 s10, 268435456, 0
    s_cselect_b32 s14, 5308416, 0
    s_add_u32 m0, s32, s35
    s_add_u32 s37, s33, 1024
    buffer_load_dwordx4 v1, s[8:11], s33 offen lds
    v_mfma_f32_32x32x16_bf16 v[64:79], v[20:23], v[12:15], v[64:79]
    s_add_u32 m0, m0, 1024
    s_add_u32 s33, s33, 2048
    buffer_load_dwordx4 v1, s[8:11], s37 offen lds
    s_add_u32 m0, s32, s34
    s_nop 0
    buffer_load_dwordx4 v3, s[12:15], s38 offen lds
    v_mfma_f32_32x32x16_bf16 v[80:95], v[36:39], v[12:15], v[80:95]
    s_add_u32 s38, s38, 36864
    s_add_u32 s32, s32, 26624
    s_cmp_eq_u32 s32, 79872
    s_cselect_b32 s32, 0, s32
    ds_read_b64_tr_b16 v[26:27], v4 offset:2432
    v_mfma_f32_32x32x16_bf16 v[96:111], v[40:43], v[12:15], v[96:111]
    ds_read_b64_tr_b16 v[28:29], v4 offset:192
    ds_read_b64_tr_b16 v[30:31], v4 offset:2496
    ds_read_b64_tr_b16 v[32:33], v4 offset:256
    ds_read_b64_tr_b16 v[34:35], v4 offset:2560
    v_mfma_f32_32x32x16_bf16 v[112:127], v[44:47], v[12:15], v[112:127]
    ds_read_b64_tr_b16 v[16:17], v4 offset:0
    ds_read_b64_tr_b16 v[18:19], v4 offset:2304
    ds_read_b64_tr_b16 v[20:21], v4 offset:64
    ds_read_b64_tr_b16 v[22:23], v4 offset:2368
    s_add_u32 s31, s31, 1
    s_cmp_lt_u32 s31, 18
    s_cbranch_scc1 K2A_LOOP
    s_mov_b32 s10, 268435456
    s_mov_b32 s14, 5308416
    s_waitcnt lgkmcnt(0)
    s_lshl_b32 s33, s24, 6
    s_lshl_b32 s34, s25, 2
    s_add_u32 s33, s33, s34
    s_add_u32 s33, s33, s26
    s_mul_i32 s33, s33, 18
    s_mul_i32 s34, s28, 9
    s_add_u32 s33, s33, s34
    s_add_u32 s33, s33, 0
    s_lshl_b32 s33, s33, 11
    s_add_u32 s33, s33, 36700160
    v_and_b32 v1, 63, v0
    v_lshlrev_b32 v1, 4, v1
    s_nop 7
    v_cvt_pk_bf16_f32 v8, v48, v49
    v_cvt_pk_bf16_f32 v9, v50, v51
    v_cvt_pk_bf16_f32 v10, v52, v53
    v_cvt_pk_bf16_f32 v11, v54, v55
    v_cvt_pk_bf16_f32 v12, v56, v57
    v_cvt_pk_bf16_f32 v13, v58, v59
    v_cvt_pk_bf16_f32 v14, v60, v61
    v_cvt_pk_bf16_f32 v15, v62, v63
    buffer_store_dwordx4 v[8:11], v1, s[8:11], s33 offen sc1
    buffer_store_dwordx4 v[12:15], v1, s[8:11], s33 offen offset:1024 sc1
    s_add_u32 s33, s33, 2048
    v_cvt_pk_bf16_f32 v16, v64, v65
    v_cvt_pk_bf16_f32 v17, v66, v67
    v_cvt_pk_bf16_f32 v18, v68, v69
    v_cvt_pk_bf16_f32 v19, v70, v71
    v_cvt_pk_bf16_f32 v20, v72, v73
    v_cvt_pk_bf16_f32 v21, v74, v75
    v_cvt_pk_bf16_f32 v22, v76, v77
    v_cvt_pk_bf16_f32 v23, v78, v79
    buffer_store_dwordx4 v[16:19], v1, s[8:11], s33 offen sc1
    buffer_store_dwordx4 v[20:23], v1, s[8:11], s33 offen offset:1024 sc1
    s_add_u32 s33, s33, 2048
    v_cvt_pk_bf16_f32 v8, v80, v81
    v_cvt_pk_bf16_f32 v9, v82, v83
    v_cvt_pk_bf16_f32 v10, v84, v85
    v_cvt_pk_bf16_f32 v11, v86, v87
    v_cvt_pk_bf16_f32 v12, v88, v89
    v_cvt_pk_bf16_f32 v13, v90, v91
    v_cvt_pk_bf16_f32 v14, v92, v93
    v_cvt_pk_bf16_f32 v15, v94, v95
    buffer_store_dwordx4 v[8:11], v1, s[8:11], s33 offen sc1
    buffer_store_dwordx4 v[12:15], v1, s[8:11], s33 offen offset:1024 sc1
    s_add_u32 s33, s33, 2048
    v_cvt_pk_bf16_f32 v16, v96, v97
    v_cvt_pk_bf16_f32 v17, v98, v99
    v_cvt_pk_bf16_f32 v18, v100, v101
    v_cvt_pk_bf16_f32 v19, v102, v103
    v_cvt_pk_bf16_f32 v20, v104, v105
    v_cvt_pk_bf16_f32 v21, v106, v107
    v_cvt_pk_bf16_f32 v22, v108, v109
    v_cvt_pk_bf16_f32 v23, v110, v111
    buffer_store_dwordx4 v[16:19], v1, s[8:11], s33 offen sc1
    buffer_store_dwordx4 v[20:23], v1, s[8:11], s33 offen offset:1024 sc1
    s_add_u32 s33, s33, 2048
    v_cvt_pk_bf16_f32 v8, v112, v113
    v_cvt_pk_bf16_f32 v9, v114, v115
    v_cvt_pk_bf16_f32 v10, v116, v117
    v_cvt_pk_bf16_f32 v11, v118, v119
    v_cvt_pk_bf16_f32 v12, v120, v121
    v_cvt_pk_bf16_f32 v13, v122, v123
    v_cvt_pk_bf16_f32 v14, v124, v125
    v_cvt_pk_bf16_f32 v15, v126, v127
    buffer_store_dwordx4 v[8:11], v1, s[8:11], s33 offen sc1
    buffer_store_dwordx4 v[12:15], v1, s[8:11], s33 offen offset:1024 sc1
    s_add_u32 s33, s33, 2048
    s_waitcnt vmcnt(0)
    s_endpgm
K2_B:
    s_mul_i32 s39, s26, 224
    s_add_u32 s39, s39, 256
    s_lshl_b32 s34, s39, 4
    s_add_u32 s34, s34, 8192
    v_add_u32 v20, 0, v2
    v_add_u32 v20, s39, v20
    v_mul_u32_u24 v21, 1821, v20
    v_lshrrev_b32 v21, 16, v21
    v_mul_u32_u24 v22, 36, v21
    v_sub_u32 v22, v20, v22
    v_mul_u32_u24 v21, 1152, v21
    v_lshl_add_u32 v1, v22, 4, v21
    v_add_u32 v20, 64, v2
    v_add_u32 v20, s39, v20
    v_mul_u32_u24 v21, 1821, v20
    v_lshrrev_b32 v21, 16, v21
    v_mul_u32_u24 v22, 36, v21
    v_sub_u32 v22, v20, v22
    v_mul_u32_u24 v21, 1152, v21
    v_lshl_add_u32 v3, v22, 4, v21
    v_add_u32 v20, 128, v2
    v_add_u32 v20, s39, v20
    v_mul_u32_u24 v21, 1821, v20
    v_lshrrev_b32 v21, 16, v21
    v_mul_u32_u24 v22, 36, v21
    v_sub_u32 v22, v20, v22
    v_mul_u32_u24 v21, 1152, v21
    v_lshl_add_u32 v112, v22, 4, v21
    v_add_u32 v20, 192, v2
    v_add_u32 v20, s39, v20
    v_mul_u32_u24 v21, 1821, v20
    v_lshrrev_b32 v21, 16, v21
    v_mul_u32_u24 v22, 36, v21
    v_sub_u32 v22, v20, v22
    v_mul_u32_u24 v21, 1152, v21
    v_lshl_add_u32 v113, v22, 4, v21
    s_add_u32 s36, s32, s34
    s_add_u32 m0, s36, 0
    s_nop 0
    buffer_load_dwordx4 v1, s[12:15], s38 offen lds
    s_add_u32 m0, s36, 1024
    s_nop 0
    buffer_load_dwordx4 v3, s[12:15], s38 offen lds
    s_add_u32 m0, s36, 2048
    s_nop 0
    buffer_load_dwordx4 v112, s[12:15], s38 offen lds
    s_add_u32 m0, s36, 3072
    s_mov_b32 exec_hi, 0
    buffer_load_dwordx4 v113, s[12:15], s38 offen lds
    s_mov_b32 exec_hi, -1
    s_add_u32 s38, s38, 36864
    s_add_u32 s32, s32, 26624
    s_cmp_eq_u32 s32, 79872
    s_cselect_b32 s32, 0, s32
    s_add_u32 s36, s32, s34
    s_add_u32 m0, s36, 0
    s_nop 0
    buffer_load_dwordx4 v1, s[12:15], s38 offen lds
    s_add_u32 m0, s36, 1024
    s_nop 0
    buffer_load_dwordx4 v3, s[12:15], s38 offen lds
    s_add_u32 m0, s36, 2048
    s_nop 0
    buffer_load_dwordx4 v112, s[12:15], s38 offen lds
    s_add_u32 m0, s36, 3072
    s_mov_b32 exec_hi, 0
    buffer_load_dwordx4 v113, s[12:15], s38 offen lds
    s_mov_b32 exec_hi, -1
    s_add_u32 s38, s38, 36864
    s_add_u32 s32, s32, 26624
    s_cmp_eq_u32 s32, 79872
    s_cselect_b32 s32, 0, s32
    s_add_u32 s36, s32, s34
    s_add_u32 m0, s36, 0
    s_nop 0
    buffer_load_dwordx4 v1, s[12:15], s38 offen lds
    s_add_u32 m0, s36, 1024
    s_nop 0
    buffer_load_dwordx4 v3, s[12:15], s38 offen lds
    s_add_u32 m0, s36, 2048
    s_nop 0
    buffer_load_dwordx4 v112, s[12:15], s38 offen lds
    s_add_u32 m0, s36, 3072
    s_mov_b32 exec_hi, 0
    buffer_load_dwordx4 v113, s[12:15], s38 offen lds
    s_mov_b32 exec_hi, -1
    s_add_u32 s38, s38, 36864
    s_add_u32 s32, s32, 26624
    s_cmp_eq_u32 s32, 79872
    s_cselect_b32 s32, 0, s32
    v_mov_b32 v48, 0
    v_mov_b32 v49, 0
    v_mov_b32 v50, 0
    v_mov_b32 v51, 0
    v_mov_b32 v52, 0
    v_mov_b32 v53, 0
    v_mov_b32 v54, 0
    v_mov_b32 v55, 0
    v_mov_b32 v56, 0
    v_mov_b32 v57, 0
    v_mov_b32 v58, 0
    v_mov_b32 v59, 0
    v_mov_b32 v60, 0
    v_mov_b32 v61, 0
    v_mov_b32 v62, 0
    v_mov_b32 v63, 0
    v_mov_b32 v64, 0
    v_mov_b32 v65, 0
    v_mov_b32 v66, 0
    v_mov_b32 v67, 0
    v_mov_b32 v68, 0
    v_mov_b32 v69, 0
    v_mov_b32 v70, 0
    v_mov_b32 v71, 0
    v_mov_b32 v72, 0
    v_mov_b32 v73, 0
    v_mov_b32 v74, 0
    v_mov_b32 v75, 0
    v_mov_b32 v76, 0
    v_mov_b32 v77, 0
    v_mov_b32 v78, 0
    v_mov_b32 v79, 0
    v_mov_b32 v80, 0
    v_mov_b32 v81, 0
    v_mov_b32 v82, 0
    v_mov_b32 v83, 0
    v_mov_b32 v84, 0
    v_mov_b32 v85, 0
    v_mov_b32 v86, 0
    v_mov_b32 v87, 0
    v_mov_b32 v88, 0
    v_mov_b32 v89, 0
    v_mov_b32 v90, 0
    v_mov_b32 v91, 0
    v_mov_b32 v92, 0
    v_mov_b32 v93, 0
    v_mov_b32 v94, 0
    v_mov_b32 v95, 0
    v_mov_b32 v96, 0
    v_mov_b32 v97, 0
    v_mov_b32 v98, 0
    v_mov_b32 v99, 0
    v_mov_b32 v100, 0
    v_mov_b32 v101, 0
    v_mov_b32 v102, 0
    v_mov_b32 v103, 0
    v_mov_b32 v104, 0
    v_mov_b32 v105, 0
    v_mov_b32 v106, 0
    v_mov_b32 v107, 0
    v_mov_b32 v108, 0
    v_mov_b32 v109, 0
    v_mov_b32 v110, 0
    v_mov_b32 v111, 0
    s_waitcnt vmcnt(8)
    s_barrier
    ds_read_b128 v[8:11], v6 offset:0
    ds_read_b64_tr_b16 v[16:17], v4 offset:0
    ds_read_b64_tr_b16 v[18:19], v4 offset:2304
    ds_read_b64_tr_b16 v[20:21], v4 offset:64
    ds_read_b64_tr_b16 v[22:23], v4 offset:2368
    ds_read_b64_tr_b16 v[24:25], v4 offset:128
    ds_read_b64_tr_b16 v[26:27], v4 offset:2432
    ds_read_b64_tr_b16 v[28:29], v4 offset:192
    ds_read_b64_tr_b16 v[30:31], v4 offset:2496
    s_mov_b32 s31, 0
K2B_LOOP:
    s_waitcnt lgkmcnt(0)
    v_mfma_f32_32x32x16_bf16 v[48:63], v[16:19], v[8:11], v[48:63]
    ds_read_b128 v[12:15], v6 offset:1024
    ds_read_b64_tr_b16 v[32:33], v4 offset:9216
    ds_read_b64_tr_b16 v[34:35], v4 offset:11520
    v_mfma_f32_32x32x16_bf16 v[64:79], v[20:23], v[8:11], v[64:79]
    ds_read_b64_tr_b16 v[36:37], v4 offset:9280
    ds_read_b64_tr_b16 v[38:39], v4 offset:11584
    v_mfma_f32_32x32x16_bf16 v[80:95], v[24:27], v[8:11], v[80:95]
    ds_read_b64_tr_b16 v[40:41], v4 offset:9344
    ds_read_b64_tr_b16 v[42:43], v4 offset:11648
    v_mfma_f32_32x32x16_bf16 v[96:111], v[28:31], v[8:11], v[96:111]
    ds_read_b64_tr_b16 v[44:45], v4 offset:9408
    ds_read_b64_tr_b16 v[46:47], v4 offset:11712
    s_add_u32 s30, s30, 26624
    s_cmp_eq_u32 s30, 79872
    s_cselect_b32 s30, 0, s30
    s_waitcnt vmcnt(4) lgkmcnt(0)
    s_barrier
    v_add_u32 v4, s30, v5
    v_add_u32 v6, s30, v7
    v_mfma_f32_32x32x16_bf16 v[48:63], v[32:35], v[12:15], v[48:63]
    ds_read_b128 v[8:11], v6 offset:0
    ds_read_b64_tr_b16 v[16:17], v4 offset:0
    s_cmp_lt_u32 s31, 15
    s_cselect_b32 s10, 268435456, 0
    s_cselect_b32 s14, 5308416, 0
    s_add_u32 s36, s32, s34
    s_add_u32 m0, s36, 0
    s_nop 0
    buffer_load_dwordx4 v1, s[12:15], s38 offen lds
    v_mfma_f32_32x32x16_bf16 v[64:79], v[36:39], v[12:15], v[64:79]
    s_add_u32 m0, s36, 1024
    s_nop 0
    buffer_load_dwordx4 v3, s[12:15], s38 offen lds
    s_add_u32 m0, s36, 2048
    s_nop 0
    buffer_load_dwordx4 v112, s[12:15], s38 offen lds
    s_add_u32 m0, s36, 3072
    s_mov_b32 exec_hi, 0
    buffer_load_dwordx4 v113, s[12:15], s38 offen lds
    s_mov_b32 exec_hi, -1
    v_mfma_f32_32x32x16_bf16 v[80:95], v[40:43], v[12:15], v[80:95]
    s_add_u32 s38, s38, 36864
    s_add_u32 s32, s32, 26624
    s_cmp_eq_u32 s32, 79872
    s_cselect_b32 s32, 0, s32
    ds_read_b64_tr_b16 v[18:19], v4 offset:2304
    ds_read_b64_tr_b16 v[20:21], v4 offset:64
    v_mfma_f32_32x32x16_bf16 v[96:111], v[44:47], v[12:15], v[96:111]
    ds_read_b64_tr_b16 v[22:23], v4 offset:2368
    ds_read_b64_tr_b16 v[24:25], v4 offset:128
    ds_read_b64_tr_b16 v[26:27], v4 offset:2432
    ds_read_b64_tr_b16 v[28:29], v4 offset:192
    ds_read_b64_tr_b16 v[30:31], v4 offset:2496
    s_add_u32 s31, s31, 1
    s_cmp_lt_u32 s31, 18
    s_cbranch_scc1 K2B_LOOP
    s_mov_b32 s10, 268435456
    s_mov_b32 s14, 5308416
    s_waitcnt lgkmcnt(0)
    s_lshl_b32 s33, s24, 6
    s_lshl_b32 s34, s25, 2
    s_add_u32 s33, s33, s34
    s_add_u32 s33, s33, s26
    s_mul_i32 s33, s33, 18
    s_mul_i32 s34, s28, 9
    s_add_u32 s33, s33, s34
    s_add_u32 s33, s33, 5
    s_lshl_b32 s33, s33, 11
    s_add_u32 s33, s33, 36700160
    v_and_b32 v1, 63, v0
    v_lshlrev_b32 v1, 4, v1
    s_nop 7
    v_cvt_pk_bf16_f32 v8, v48, v49
    v_cvt_pk_bf16_f32 v9, v50, v51
    v_cvt_pk_bf16_f32 v10, v52, v53
    v_cvt_pk_bf16_f32 v11, v54, v55
    v_cvt_pk_bf16_f32 v12, v56, v57
    v_cvt_pk_bf16_f32 v13, v58, v59
    v_cvt_pk_bf16_f32 v14, v60, v61
    v_cvt_pk_bf16_f32 v15, v62, v63
    buffer_store_dwordx4 v[8:11], v1, s[8:11], s33 offen sc1
    buffer_store_dwordx4 v[12:15], v1, s[8:11], s33 offen offset:1024 sc1
    s_add_u32 s33, s33, 2048
    v_cvt_pk_bf16_f32 v16, v64, v65
    v_cvt_pk_bf16_f32 v17, v66, v67
    v_cvt_pk_bf16_f32 v18, v68, v69
    v_cvt_pk_bf16_f32 v19, v70, v71
    v_cvt_pk_bf16_f32 v20, v72, v73
    v_cvt_pk_bf16_f32 v21, v74, v75
    v_cvt_pk_bf16_f32 v22, v76, v77
    v_cvt_pk_bf16_f32 v23, v78, v79
    buffer_store_dwordx4 v[16:19], v1, s[8:11], s33 offen sc1
    buffer_store_dwordx4 v[20:23], v1, s[8:11], s33 offen offset:1024 sc1
    s_add_u32 s33, s33, 2048
    v_cvt_pk_bf16_f32 v8, v80, v81
    v_cvt_pk_bf16_f32 v9, v82, v83
    v_cvt_pk_bf16_f32 v10, v84, v85
    v_cvt_pk_bf16_f32 v11, v86, v87
    v_cvt_pk_bf16_f32 v12, v88, v89
    v_cvt_pk_bf16_f32 v13, v90, v91
    v_cvt_pk_bf16_f32 v14, v92, v93
    v_cvt_pk_bf16_f32 v15, v94, v95
    buffer_store_dwordx4 v[8:11], v1, s[8:11], s33 offen sc1
    buffer_store_dwordx4 v[12:15], v1, s[8:11], s33 offen offset:1024 sc1
    s_add_u32 s33, s33, 2048
    v_cvt_pk_bf16_f32 v16, v96, v97
    v_cvt_pk_bf16_f32 v17, v98, v99
    v_cvt_pk_bf16_f32 v18, v100, v101
    v_cvt_pk_bf16_f32 v19, v102, v103
    v_cvt_pk_bf16_f32 v20, v104, v105
    v_cvt_pk_bf16_f32 v21, v106, v107
    v_cvt_pk_bf16_f32 v22, v108, v109
    v_cvt_pk_bf16_f32 v23, v110, v111
    buffer_store_dwordx4 v[16:19], v1, s[8:11], s33 offen sc1
    buffer_store_dwordx4 v[20:23], v1, s[8:11], s33 offen offset:1024 sc1
    s_add_u32 s33, s33, 2048
    s_waitcnt vmcnt(0)
    s_endpgm
K2_FFT:
    s_cmp_ge_u32 s3, 4
    s_cbranch_scc1 K2_END
    s_setprio 0
    s_sub_u32 s24, s2, 0
    s_lshl_b32 s25, s24, 2
    s_add_u32 s25, s25, s3
    v_and_b32 v3, 31, v2
    v_lshrrev_b32 v1, 5, v2
    v_lshlrev_b32 v4, 10, v1
    v_lshl_add_u32 v4, v3, 2, v4
    v_lshlrev_b32 v5, 4, v2
    v_lshlrev_b32 v6, 3, v2
    s_lshl_b32 s26, s25, 13
    s_add_u32 s27, s26, 2359296
    s_add_u32 s28, s27, 4096
    s_add_u32 s29, s26, 5111808
    s_mul_i32 s33, s3, 10240
    s_add_u32 s34, s33, 10682368
    s_mul_i32 s36, s3, 4608
    s_add_u32 s36, s36, 40960
    s_add_u32 m0, s33, 0
    s_add_u32 s37, s34, 0
    buffer_load_dwordx4 v5, s[8:11], s37 offen lds
    s_add_u32 m0, s33, 1024
    s_add_u32 s37, s34, 1024
    buffer_load_dwordx4 v5, s[8:11], s37 offen lds
    s_add_u32 m0, s33, 2048
    s_add_u32 s37, s34, 2048
    buffer_load_dwordx4 v5, s[8:11], s37 offen lds
    s_add_u32 m0, s33, 3072
    s_add_u32 s37, s34, 3072
    buffer_load_dwordx4 v5, s[8:11], s37 offen lds
    s_add_u32 m0, s33, 4096
    s_add_u32 s37, s34, 4096
    buffer_load_dwordx4 v5, s[8:11], s37 offen lds
    s_add_u32 m0, s33, 5120
    s_add_u32 s37, s34, 5120
    buffer_load_dwordx4 v5, s[8:11], s37 offen lds
    s_add_u32 m0, s33, 6144
    s_add_u32 s37, s34, 6144
    buffer_load_dwordx4 v5, s[8:11], s37 offen lds
    s_add_u32 m0, s33, 7168
    s_add_u32 s37, s34, 7168
    buffer_load_dwordx4 v5, s[8:11], s37 offen lds
    s_add_u32 m0, s33, 8192
    s_add_u32 s37, s34, 8192
    buffer_load_dwordx4 v5, s[8:11], s37 offen lds
    s_add_u32 m0, s33, 9216
    s_add_u32 s37, s34, 9216
    buffer_load_dwordx4 v5, s[8:11], s37 offen lds
    buffer_load_dword v16, v4, s[8:11], s27 offen offset:0
    buffer_load_dword v17, v4, s[8:11], s27 offen offset:256
    buffer_load_dword v18, v4, s[8:11], s27 offen offset:512
    buffer_load_dword v19, v4, s[8:11], s27 offen offset:768
    buffer_load_dword v20, v4, s[8:11], s27 offen offset:2048
    buffer_load_dword v21, v4, s[8:11], s27 offen offset:2304
    buffer_load_dword v22, v4, s[8:11], s27 offen offset:2560
    buffer_load_dword v23, v4, s[8:11], s27 offen offset:2816
    buffer_load_dword v24, v4, s[8:11], s28 offen offset:0
    buffer_load_dword v25, v4, s[8:11], s28 offen offset:256
    buffer_load_dword v26, v4, s[8:11], s28 offen offset:512
    buffer_load_dword v27, v4, s[8:11], s28 offen offset:768
    buffer_load_dword v28, v4, s[8:11], s28 offen offset:2048
    buffer_load_dword v29, v4, s[8:11], s28 offen offset:2304
    buffer_load_dword v30, v4, s[8:11], s28 offen offset:2560
    buffer_load_dword v31, v4, s[8:11], s28 offen offset:2816
    buffer_load_dword v32, v4, s[8:11], s27 offen offset:128
    buffer_load_dword v33, v4, s[8:11], s27 offen offset:384
    buffer_load_dword v34, v4, s[8:11], s27 offen offset:640
    buffer_load_dword v35, v4, s[8:11], s27 offen offset:896
    buffer_load_dword v36, v4, s[8:11], s27 offen offset:2176
    buffer_load_dword v37, v4, s[8:11], s27 offen offset:2432
    buffer_load_dword v38, v4, s[8:11], s27 offen offset:2688
    buffer_load_dword v39, v4, s[8:11], s27 offen offset:2944
    buffer_load_dword v40, v4, s[8:11], s28 offen offset:128
    buffer_load_dword v41, v4, s[8:11], s28 offen offset:384
    buffer_load_dword v42, v4, s[8:11], s28 offen offset:640
    buffer_load_dword v43, v4, s[8:11], s28 offen offset:896
    buffer_load_dword v44, v4, s[8:11], s28 offen offset:2176
    buffer_load_dword v45, v4, s[8:11], s28 offen offset:2432
    buffer_load_dword v46, v4, s[8:11], s28 offen offset:2688
    buffer_load_dword v47, v4, s[8:11], s28 offen offset:2944
    s_add_u32 s37, s29, 0
    buffer_load_dwordx2 v[112:113], v6, s[8:11], s37 offen offset:0
    s_add_u32 s37, s29, 0
    buffer_load_dwordx2 v[114:115], v6, s[8:11], s37 offen offset:512
    s_add_u32 s37, s29, 0
    buffer_load_dwordx2 v[116:117], v6, s[8:11], s37 offen offset:1024
    s_add_u32 s37, s29, 0
    buffer_load_dwordx2 v[118:119], v6, s[8:11], s37 offen offset:1536
    s_add_u32 s37, s29, 0
    buffer_load_dwordx2 v[120:121], v6, s[8:11], s37 offen offset:2048
    s_add_u32 s37, s29, 0
    buffer_load_dwordx2 v[122:123], v6, s[8:11], s37 offen offset:2560
    s_add_u32 s37, s29, 0
    buffer_load_dwordx2 v[124:125], v6, s[8:11], s37 offen offset:3072
    s_add_u32 s37, s29, 0
    buffer_load_dwordx2 v[126:127], v6, s[8:11], s37 offen offset:3584
    s_add_u32 s37, s29, 4096
    buffer_load_dwordx2 v[64:65], v6, s[8:11], s37 offen offset:0
    s_add_u32 s37, s29, 4096
    buffer_load_dwordx2 v[66:67], v6, s[8:11], s37 offen offset:512
    s_add_u32 s37, s29, 4096
    buffer_load_dwordx2 v[68:69], v6, s[8:11], s37 offen offset:1024
    s_add_u32 s37, s29, 4096
    buffer_load_dwordx2 v[70:71], v6, s[8:11], s37 offen offset:1536
    s_add_u32 s37, s29, 4096
    buffer_load_dwordx2 v[72:73], v6, s[8:11], s37 offen offset:2048
    s_add_u32 s37, s29, 4096
    buffer_load_dwordx2 v[74:75], v6, s[8:11], s37 offen offset:2560
    s_add_u32 s37, s29, 4096
    buffer_load_dwordx2 v[76:77], v6, s[8:11], s37 offen offset:3072
    s_add_u32 s37, s29, 4096
    buffer_load_dwordx2 v[78:79], v6, s[8:11], s37 offen offset:3584
    s_waitcnt vmcnt(16)
    s_barrier
    ds_read_b128 v[48:51], v5 offset:0
    ds_read_b128 v[52:55], v5 offset:1024
    ds_read_b128 v[56:59], v5 offset:2048
    ds_read_b128 v[60:63], v5 offset:3072
    s_waitcnt lgkmcnt(0)
    v_mfma_f32_32x32x16_bf16 v[80:95], v[16:19], v[48:51], 0
    v_mfma_f32_32x32x16_bf16 v[80:95], v[20:23], v[52:55], v[80:95]
    v_mfma_f32_32x32x16_bf16 v[80:95], v[24:27], v[56:59], v[80:95]
    v_mfma_f32_32x32x16_bf16 v[80:95], v[28:31], v[60:63], v[80:95]
    ds_read_b128 v[48:51], v5 offset:4096
    ds_read_b128 v[52:55], v5 offset:5120
    ds_read_b128 v[56:59], v5 offset:6144
    ds_read_b128 v[60:63], v5 offset:7168
    s_waitcnt lgkmcnt(0)
    v_mfma_f32_32x32x16_bf16 v[96:111], v[16:19], v[48:51], 0
    v_mfma_f32_32x32x16_bf16 v[96:111], v[20:23], v[52:55], v[96:111]
    v_mfma_f32_32x32x16_bf16 v[96:111], v[24:27], v[56:59], v[96:111]
    v_mfma_f32_32x32x16_bf16 v[96:111], v[28:31], v[60:63], v[96:111]
    s_nop 7
    s_nop 3
    ds_read_b128 v[48:51], v5 offset:24576
    ds_read_b128 v[52:55], v5 offset:25600
    ds_read_b128 v[56:59], v5 offset:26624
    ds_read_b128 v[60:63], v5 offset:27648
    s_waitcnt lgkmcnt(2)
    v_mul_f32 v8, v80, v48
    v_mul_f32 v12, v80, v52
    v_fma_f32 v8, -v96, v52, v8
    v_fma_f32 v12, v96, v48, v12
    v_mul_f32 v9, v81, v49
    v_mul_f32 v13, v81, v53
    v_fma_f32 v9, -v97, v53, v9
    v_fma_f32 v13, v97, v49, v13
    v_mul_f32 v10, v82, v50
    v_mul_f32 v14, v82, v54
    v_fma_f32 v10, -v98, v54, v10
    v_fma_f32 v14, v98, v50, v14
    v_mul_f32 v11, v83, v51
    v_mul_f32 v15, v83, v55
    v_fma_f32 v11, -v99, v55, v11
    v_fma_f32 v15, v99, v51, v15
    ds_read_b128 v[48:51], v5 offset:28672
    ds_read_b128 v[52:55], v5 offset:29696
    v_cvt_pk_bf16_f32 v16, v8, v9
    v_cvt_pk_bf16_f32 v17, v10, v11
    v_cvt_pk_bf16_f32 v24, v12, v13
    v_cvt_pk_bf16_f32 v25, v14, v15
    s_waitcnt lgkmcnt(2)
    v_mul_f32 v8, v84, v56
    v_mul_f32 v12, v84, v60
    v_fma_f32 v8, -v100, v60, v8
    v_fma_f32 v12, v100, v56, v12
    v_mul_f32 v9, v85, v57
    v_mul_f32 v13, v85, v61
    v_fma_f32 v9, -v101, v61, v9
    v_fma_f32 v13, v101, v57, v13
    v_mul_f32 v10, v86, v58
    v_mul_f32 v14, v86, v62
    v_fma_f32 v10, -v102, v62, v10
    v_fma_f32 v14, v102, v58, v14
    v_mul_f32 v11, v87, v59
    v_mul_f32 v15, v87, v63
    v_fma_f32 v11, -v103, v63, v11
    v_fma_f32 v15, v103, v59, v15
    ds_read_b128 v[56:59], v5 offset:30720
    ds_read_b128 v[60:63], v5 offset:31744
    v_cvt_pk_bf16_f32 v18, v8, v9
    v_cvt_pk_bf16_f32 v19, v10, v11
    v_cvt_pk_bf16_f32 v26, v12, v13
    v_cvt_pk_bf16_f32 v27, v14, v15
    s_waitcnt lgkmcnt(2)
    v_mul_f32 v8, v88, v48
    v_mul_f32 v12, v88, v52
    v_fma_f32 v8, -v104, v52, v8
    v_fma_f32 v12, v104, v48, v12
    v_mul_f32 v9, v89, v49
    v_mul_f32 v13, v89, v53
    v_fma_f32 v9, -v105, v53, v9
    v_fma_f32 v13, v105, v49, v13
    v_mul_f32 v10, v90, v50
    v_mul_f32 v14, v90, v54
    v_fma_f32 v10, -v106, v54, v10
    v_fma_f32 v14, v106, v50, v14
    v_mul_f32 v11, v91, v51
    v_mul_f32 v15, v91, v55
    v_fma_f32 v11, -v107, v55, v11
    v_fma_f32 v15, v107, v51, v15
    v_cvt_pk_bf16_f32 v20, v8, v9
    v_cvt_pk_bf16_f32 v21, v10, v11
    v_cvt_pk_bf16_f32 v28, v12, v13
    v_cvt_pk_bf16_f32 v29, v14, v15
    s_waitcnt lgkmcnt(0)
    v_mul_f32 v8, v92, v56
    v_mul_f32 v12, v92, v60
    v_fma_f32 v8, -v108, v60, v8
    v_fma_f32 v12, v108, v56, v12
    v_mul_f32 v9, v93, v57
    v_mul_f32 v13, v93, v61
    v_fma_f32 v9, -v109, v61, v9
    v_fma_f32 v13, v109, v57, v13
    v_mul_f32 v10, v94, v58
    v_mul_f32 v14, v94, v62
    v_fma_f32 v10, -v110, v62, v10
    v_fma_f32 v14, v110, v58, v14
    v_mul_f32 v11, v95, v59
    v_mul_f32 v15, v95, v63
    v_fma_f32 v11, -v111, v63, v11
    v_fma_f32 v15, v111, v59, v15
    v_cvt_pk_bf16_f32 v22, v8, v9
    v_cvt_pk_bf16_f32 v23, v10, v11
    v_cvt_pk_bf16_f32 v30, v12, v13
    v_cvt_pk_bf16_f32 v31, v14, v15
    ds_read_b128 v[48:51], v5 offset:0
    ds_read_b128 v[52:55], v5 offset:1024
    ds_read_b128 v[56:59], v5 offset:2048
    ds_read_b128 v[60:63], v5 offset:3072
    s_waitcnt lgkmcnt(0)
    v_mfma_f32_32x32x16_bf16 v[80:95], v[32:35], v[48:51], 0
    v_mfma_f32_32x32x16_bf16 v[80:95], v[36:39], v[52:55], v[80:95]
    v_mfma_f32_32x32x16_bf16 v[80:95], v[40:43], v[56:59], v[80:95]
    v_mfma_f32_32x32x16_bf16 v[80:95], v[44:47], v[60:63], v[80:95]
    ds_read_b128 v[48:51], v5 offset:4096
    ds_read_b128 v[52:55], v5 offset:5120
    ds_read_b128 v[56:59], v5 offset:6144
    ds_read_b128 v[60:63], v5 offset:7168
    s_waitcnt lgkmcnt(0)
    v_mfma_f32_32x32x16_bf16 v[96:111], v[32:35], v[48:51], 0
    v_mfma_f32_32x32x16_bf16 v[96:111], v[36:39], v[52:55], v[96:111]
    v_mfma_f32_32x32x16_bf16 v[96:111], v[40:43], v[56:59], v[96:111]
    v_mfma_f32_32x32x16_bf16 v[96:111], v[44:47], v[60:63], v[96:111]
    s_nop 7
    s_nop 3
    ds_read_b128 v[48:51], v5 offset:32768
    ds_read_b128 v[52:55], v5 offset:33792
    ds_read_b128 v[56:59], v5 offset:34816
    ds_read_b128 v[60:63], v5 offset:35840
    s_waitcnt lgkmcnt(2)
    v_mul_f32 v8, v80, v48
    v_mul_f32 v12, v80, v52
    v_fma_f32 v8, -v96, v52, v8
    v_fma_f32 v12, v96, v48, v12
    v_mul_f32 v9, v81, v49
    v_mul_f32 v13, v81, v53
    v_fma_f32 v9, -v97, v53, v9
    v_fma_f32 v13, v97, v49, v13
    v_mul_f32 v10, v82, v50
    v_mul_f32 v14, v82, v54
    v_fma_f32 v10, -v98, v54, v10
    v_fma_f32 v14, v98, v50, v14
    v_mul_f32 v11, v83, v51
    v_mul_f32 v15, v83, v55
    v_fma_f32 v11, -v99, v55, v11
    v_fma_f32 v15, v99, v51, v15
    ds_read_b128 v[48:51], v5 offset:36864
    ds_read_b128 v[52:55], v5 offset:37888
    v_cvt_pk_bf16_f32 v32, v8, v9
    v_cvt_pk_bf16_f32 v33, v10, v11
    v_cvt_pk_bf16_f32 v40, v12, v13
    v_cvt_pk_bf16_f32 v41, v14, v15
    s_waitcnt lgkmcnt(2)
    v_mul_f32 v8, v84, v56
    v_mul_f32 v12, v84, v60
    v_fma_f32 v8, -v100, v60, v8
    v_fma_f32 v12, v100, v56, v12
    v_mul_f32 v9, v85, v57
    v_mul_f32 v13, v85, v61
    v_fma_f32 v9, -v101, v61, v9
    v_fma_f32 v13, v101, v57, v13
    v_mul_f32 v10, v86, v58
    v_mul_f32 v14, v86, v62
    v_fma_f32 v10, -v102, v62, v10
    v_fma_f32 v14, v102, v58, v14
    v_mul_f32 v11, v87, v59
    v_mul_f32 v15, v87, v63
    v_fma_f32 v11, -v103, v63, v11
    v_fma_f32 v15, v103, v59, v15
    ds_read_b128 v[56:59], v5 offset:38912
    ds_read_b128 v[60:63], v5 offset:39936
    v_cvt_pk_bf16_f32 v34, v8, v9
    v_cvt_pk_bf16_f32 v35, v10, v11
    v_cvt_pk_bf16_f32 v42, v12, v13
    v_cvt_pk_bf16_f32 v43, v14, v15
    s_waitcnt lgkmcnt(2)
    v_mul_f32 v8, v88, v48
    v_mul_f32 v12, v88, v52
    v_fma_f32 v8, -v104, v52, v8
    v_fma_f32 v12, v104, v48, v12
    v_mul_f32 v9, v89, v49
    v_mul_f32 v13, v89, v53
    v_fma_f32 v9, -v105, v53, v9
    v_fma_f32 v13, v105, v49, v13
    v_mul_f32 v10, v90, v50
    v_mul_f32 v14, v90, v54
    v_fma_f32 v10, -v106, v54, v10
    v_fma_f32 v14, v106, v50, v14
    v_mul_f32 v11, v91, v51
    v_mul_f32 v15, v91, v55
    v_fma_f32 v11, -v107, v55, v11
    v_fma_f32 v15, v107, v51, v15
    v_cvt_pk_bf16_f32 v36, v8, v9
    v_cvt_pk_bf16_f32 v37, v10, v11
    v_cvt_pk_bf16_f32 v44, v12, v13
    v_cvt_pk_bf16_f32 v45, v14, v15
    s_waitcnt lgkmcnt(0)
    v_mul_f32 v8, v92, v56
    v_mul_f32 v12, v92, v60
    v_fma_f32 v8, -v108, v60, v8
    v_fma_f32 v12, v108, v56, v12
    v_mul_f32 v9, v93, v57
    v_mul_f32 v13, v93, v61
    v_fma_f32 v9, -v109, v61, v9
    v_fma_f32 v13, v109, v57, v13
    v_mul_f32 v10, v94, v58
    v_mul_f32 v14, v94, v62
    v_fma_f32 v10, -v110, v62, v10
    v_fma_f32 v14, v110, v58, v14
    v_mul_f32 v11, v95, v59
    v_mul_f32 v15, v95, v63
    v_fma_f32 v11, -v111, v63, v11
    v_fma_f32 v15, v111, v59, v15
    v_cvt_pk_bf16_f32 v38, v8, v9
    v_cvt_pk_bf16_f32 v39, v10, v11
    v_cvt_pk_bf16_f32 v46, v12, v13
    v_cvt_pk_bf16_f32 v47, v14, v15
    ds_read_b128 v[48:51], v5 offset:8192
    ds_read_b128 v[52:55], v5 offset:9216
    ds_read_b128 v[56:59], v5 offset:10240
    ds_read_b128 v[60:63], v5 offset:11264
    s_waitcnt lgkmcnt(0)
    v_mfma_f32_32x32x16_bf16 v[80:95], v[48:51], v[16:19], 0
    v_mfma_f32_32x32x16_bf16 v[80:95], v[52:55], v[20:23], v[80:95]
    v_mfma_f32_32x32x16_bf16 v[80:95], v[56:59], v[32:35], v[80:95]
    v_mfma_f32_32x32x16_bf16 v[80:95], v[60:63], v[36:39], v[80:95]
    v_mfma_f32_32x32x16_bf16 v[96:111], v[48:51], v[24:27], 0
    v_mfma_f32_32x32x16_bf16 v[96:111], v[52:55], v[28:31], v[96:111]
    v_mfma_f32_32x32x16_bf16 v[96:111], v[56:59], v[40:43], v[96:111]
    v_mfma_f32_32x32x16_bf16 v[96:111], v[60:63], v[44:47], v[96:111]
    ds_read_b128 v[48:51], v5 offset:12288
    ds_read_b128 v[52:55], v5 offset:13312
    ds_read_b128 v[56:59], v5 offset:14336
    ds_read_b128 v[60:63], v5 offset:15360
    s_waitcnt lgkmcnt(0)
    v_mfma_f32_32x32x16_bf16 v[96:111], v[48:51], v[16:19], v[96:111]
    v_mfma_f32_32x32x16_bf16 v[96:111], v[52:55], v[20:23], v[96:111]
    v_mfma_f32_32x32x16_bf16 v[96:111], v[56:59], v[32:35], v[96:111]
    v_mfma_f32_32x32x16_bf16 v[96:111], v[60:63], v[36:39], v[96:111]
    v_xor_b32 v24, 0x80008000, v24
    v_xor_b32 v25, 0x80008000, v25
    v_xor_b32 v26, 0x80008000, v26
    v_xor_b32 v27, 0x80008000, v27
    v_xor_b32 v28, 0x80008000, v28
    v_xor_b32 v29, 0x80008000, v29
    v_xor_b32 v30, 0x80008000, v30
    v_xor_b32 v31, 0x80008000, v31
    v_xor_b32 v40, 0x80008000, v40
    v_xor_b32 v41, 0x80008000, v41
    v_xor_b32 v42, 0x80008000, v42
    v_xor_b32 v43, 0x80008000, v43
    v_xor_b32 v44, 0x80008000, v44
    v_xor_b32 v45, 0x80008000, v45
    v_xor_b32 v46, 0x80008000, v46
    v_xor_b32 v47, 0x80008000, v47
    s_nop 1
    v_mfma_f32_32x32x16_bf16 v[80:95], v[48:51], v[24:27], v[80:95]
    v_mfma_f32_32x32x16_bf16 v[80:95], v[52:55], v[28:31], v[80:95]
    v_mfma_f32_32x32x16_bf16 v[80:95], v[56:59], v[40:43], v[80:95]
    v_mfma_f32_32x32x16_bf16 v[80:95], v[60:63], v[44:47], v[80:95]
    s_nop 7
    s_nop 3
    s_waitcnt vmcnt(0)
    v_lshlrev_b32 v48, 16, v112
    v_and_b32 v52, 0xffff0000, v112
    v_lshlrev_b32 v49, 16, v113
    v_and_b32 v53, 0xffff0000, v113
    v_lshlrev_b32 v50, 16, v114
    v_and_b32 v54, 0xffff0000, v114
    v_lshlrev_b32 v51, 16, v115
    v_and_b32 v55, 0xffff0000, v115
    v_lshlrev_b32 v56, 16, v116
    v_and_b32 v60, 0xffff0000, v116
    v_lshlrev_b32 v57, 16, v117
    v_and_b32 v61, 0xffff0000, v117
    v_lshlrev_b32 v58, 16, v118
    v_and_b32 v62, 0xffff0000, v118
    v_lshlrev_b32 v59, 16, v119
    v_and_b32 v63, 0xffff0000, v119
    v_mul_f32 v8, v80, v48
    v_mul_f32 v12, v80, v52
    v_fma_f32 v8, -v96, v52, v8
    v_fma_f32 v12, v96, v48, v12
    v_mul_f32 v9, v81, v49
    v_mul_f32 v13, v81, v53
    v_fma_f32 v9, -v97, v53, v9
    v_fma_f32 v13, v97, v49, v13
    v_mul_f32 v10, v82, v50
    v_mul_f32 v14, v82, v54
    v_fma_f32 v10, -v98, v54, v10
    v_fma_f32 v14, v98, v50, v14
    v_mul_f32 v11, v83, v51
    v_mul_f32 v15, v83, v55
    v_fma_f32 v11, -v99, v55, v11
    v_fma_f32 v15, v99, v51, v15
    v_cvt_pk_bf16_f32 v112, v8, v9
    v_cvt_pk_bf16_f32 v113, v10, v11
    v_cvt_pk_bf16_f32 v116, v12, v13
    v_cvt_pk_bf16_f32 v117, v14, v15
    v_mul_f32 v8, v84, v56
    v_mul_f32 v12, v84, v60
    v_fma_f32 v8, -v100, v60, v8
    v_fma_f32 v12, v100, v56, v12
    v_mul_f32 v9, v85, v57
    v_mul_f32 v13, v85, v61
    v_fma_f32 v9, -v101, v61, v9
    v_fma_f32 v13, v101, v57, v13
    v_mul_f32 v10, v86, v58
    v_mul_f32 v14, v86, v62
    v_fma_f32 v10, -v102, v62, v10
    v_fma_f32 v14, v102, v58, v14
    v_mul_f32 v11, v87, v59
    v_mul_f32 v15, v87, v63
    v_fma_f32 v11, -v103, v63, v11
    v_fma_f32 v15, v103, v59, v15
    v_cvt_pk_bf16_f32 v114, v8, v9
    v_cvt_pk_bf16_f32 v115, v10, v11
    v_cvt_pk_bf16_f32 v118, v12, v13
    v_cvt_pk_bf16_f32 v119, v14, v15
    v_lshlrev_b32 v48, 16, v120
    v_and_b32 v52, 0xffff0000, v120
    v_lshlrev_b32 v49, 16, v121
    v_and_b32 v53, 0xffff0000, v121
    v_lshlrev_b32 v50, 16, v122
    v_and_b32 v54, 0xffff0000, v122
    v_lshlrev_b32 v51, 16, v123
    v_and_b32 v55, 0xffff0000, v123
    v_lshlrev_b32 v56, 16, v124
    v_and_b32 v60, 0xffff0000, v124
    v_lshlrev_b32 v57, 16, v125
    v_and_b32 v61, 0xffff0000, v125
    v_lshlrev_b32 v58, 16, v126
    v_and_b32 v62, 0xffff0000, v126
    v_lshlrev_b32 v59, 16, v127
    v_and_b32 v63, 0xffff0000, v127
    v_mul_f32 v8, v88, v48
    v_mul_f32 v12, v88, v52
    v_fma_f32 v8, -v104, v52, v8
    v_fma_f32 v12, v104, v48, v12
    v_mul_f32 v9, v89, v49
    v_mul_f32 v13, v89, v53
    v_fma_f32 v9, -v105, v53, v9
    v_fma_f32 v13, v105, v49, v13
    v_mul_f32 v10, v90, v50
    v_mul_f32 v14, v90, v54
    v_fma_f32 v10, -v106, v54, v10
    v_fma_f32 v14, v106, v50, v14
    v_mul_f32 v11, v91, v51
    v_mul_f32 v15, v91, v55
    v_fma_f32 v11, -v107, v55, v11
    v_fma_f32 v15, v107, v51, v15
    v_cvt_pk_bf16_f32 v120, v8, v9
    v_cvt_pk_bf16_f32 v121, v10, v11
    v_cvt_pk_bf16_f32 v124, v12, v13
    v_cvt_pk_bf16_f32 v125, v14, v15
    v_mul_f32 v8, v92, v56
    v_mul_f32 v12, v92, v60
    v_fma_f32 v8, -v108, v60, v8
    v_fma_f32 v12, v108, v56, v12
    v_mul_f32 v9, v93, v57
    v_mul_f32 v13, v93, v61
    v_fma_f32 v9, -v109, v61, v9
    v_fma_f32 v13, v109, v57, v13
    v_mul_f32 v10, v94, v58
    v_mul_f32 v14, v94, v62
    v_fma_f32 v10, -v110, v62, v10
    v_fma_f32 v14, v110, v58, v14
    v_mul_f32 v11, v95, v59
    v_mul_f32 v15, v95, v63
    v_fma_f32 v11, -v111, v63, v11
    v_fma_f32 v15, v111, v59, v15
    v_cvt_pk_bf16_f32 v122, v8, v9
    v_cvt_pk_bf16_f32 v123, v10, v11
    v_cvt_pk_bf16_f32 v126, v12, v13
    v_cvt_pk_bf16_f32 v127, v14, v15
    ds_read_b128 v[48:51], v5 offset:16384
    ds_read_b128 v[52:55], v5 offset:17408
    ds_read_b128 v[56:59], v5 offset:18432
    ds_read_b128 v[60:63], v5 offset:19456
    s_waitcnt lgkmcnt(0)
    v_mfma_f32_32x32x16_bf16 v[80:95], v[48:51], v[16:19], 0
    v_mfma_f32_32x32x16_bf16 v[80:95], v[52:55], v[20:23], v[80:95]
    v_mfma_f32_32x32x16_bf16 v[80:95], v[56:59], v[32:35], v[80:95]
    v_mfma_f32_32x32x16_bf16 v[80:95], v[60:63], v[36:39], v[80:95]
    v_xor_b32 v24, 0x80008000, v24
    v_xor_b32 v25, 0x80008000, v25
    v_xor_b32 v26, 0x80008000, v26
    v_xor_b32 v27, 0x80008000, v27
    v_xor_b32 v28, 0x80008000, v28
    v_xor_b32 v29, 0x80008000, v29
    v_xor_b32 v30, 0x80008000, v30
    v_xor_b32 v31, 0x80008000, v31
    v_xor_b32 v40, 0x80008000, v40
    v_xor_b32 v41, 0x80008000, v41
    v_xor_b32 v42, 0x80008000, v42
    v_xor_b32 v43, 0x80008000, v43
    v_xor_b32 v44, 0x80008000, v44
    v_xor_b32 v45, 0x80008000, v45
    v_xor_b32 v46, 0x80008000, v46
    v_xor_b32 v47, 0x80008000, v47
    s_nop 1
    v_mfma_f32_32x32x16_bf16 v[96:111], v[48:51], v[24:27], 0
    v_mfma_f32_32x32x16_bf16 v[96:111], v[52:55], v[28:31], v[96:111]
    v_mfma_f32_32x32x16_bf16 v[96:111], v[56:59], v[40:43], v[96:111]
    v_mfma_f32_32x32x16_bf16 v[96:111], v[60:63], v[44:47], v[96:111]
    ds_read_b128 v[48:51], v5 offset:20480
    ds_read_b128 v[52:55], v5 offset:21504
    ds_read_b128 v[56:59], v5 offset:22528
    ds_read_b128 v[60:63], v5 offset:23552
    s_waitcnt lgkmcnt(0)
    v_mfma_f32_32x32x16_bf16 v[96:111], v[48:51], v[16:19], v[96:111]
    v_mfma_f32_32x32x16_bf16 v[96:111], v[52:55], v[20:23], v[96:111]
    v_mfma_f32_32x32x16_bf16 v[96:111], v[56:59], v[32:35], v[96:111]
    v_mfma_f32_32x32x16_bf16 v[96:111], v[60:63], v[36:39], v[96:111]
    v_xor_b32 v24, 0x80008000, v24
    v_xor_b32 v25, 0x80008000, v25
    v_xor_b32 v26, 0x80008000, v26
    v_xor_b32 v27, 0x80008000, v27
    v_xor_b32 v28, 0x80008000, v28
    v_xor_b32 v29, 0x80008000, v29
    v_xor_b32 v30, 0x80008000, v30
    v_xor_b32 v31, 0x80008000, v31
    v_xor_b32 v40, 0x80008000, v40
    v_xor_b32 v41, 0x80008000, v41
    v_xor_b32 v42, 0x80008000, v42
    v_xor_b32 v43, 0x80008000, v43
    v_xor_b32 v44, 0x80008000, v44
    v_xor_b32 v45, 0x80008000, v45
    v_xor_b32 v46, 0x80008000, v46
    v_xor_b32 v47, 0x80008000, v47
    s_nop 1
    v_mfma_f32_32x32x16_bf16 v[80:95], v[48:51], v[24:27], v[80:95]
    v_mfma_f32_32x32x16_bf16 v[80:95], v[52:55], v[28:31], v[80:95]
    v_mfma_f32_32x32x16_bf16 v[80:95], v[56:59], v[40:43], v[80:95]
    v_mfma_f32_32x32x16_bf16 v[80:95], v[60:63], v[44:47], v[80:95]
    s_nop 7
    s_nop 3
    s_waitcnt vmcnt(0)
    v_lshlrev_b32 v48, 16, v64
    v_and_b32 v52, 0xffff0000, v64
    v_lshlrev_b32 v49, 16, v65
    v_and_b32 v53, 0xffff0000, v65
    v_lshlrev_b32 v50, 16, v66
    v_and_b32 v54, 0xffff0000, v66
    v_lshlrev_b32 v51, 16, v67
    v_and_b32 v55, 0xffff0000, v67
    v_lshlrev_b32 v56, 16, v68
    v_and_b32 v60, 0xffff0000, v68
    v_lshlrev_b32 v57, 16, v69
    v_and_b32 v61, 0xffff0000, v69
    v_lshlrev_b32 v58, 16, v70
    v_and_b32 v62, 0xffff0000, v70
    v_lshlrev_b32 v59, 16, v71
    v_and_b32 v63, 0xffff0000, v71
    v_mul_f32 v8, v80, v48
    v_mul_f32 v12, v80, v52
    v_fma_f32 v8, -v96, v52, v8
    v_fma_f32 v12, v96, v48, v12
    v_mul_f32 v9, v81, v49
    v_mul_f32 v13, v81, v53
    v_fma_f32 v9, -v97, v53, v9
    v_fma_f32 v13, v97, v49, v13
    v_mul_f32 v10, v82, v50
    v_mul_f32 v14, v82, v54
    v_fma_f32 v10, -v98, v54, v10
    v_fma_f32 v14, v98, v50, v14
    v_mul_f32 v11, v83, v51
    v_mul_f32 v15, v83, v55
    v_fma_f32 v11, -v99, v55, v11
    v_fma_f32 v15, v99, v51, v15
    v_cvt_pk_bf16_f32 v64, v8, v9
    v_cvt_pk_bf16_f32 v65, v10, v11
    v_cvt_pk_bf16_f32 v68, v12, v13
    v_cvt_pk_bf16_f32 v69, v14, v15
    v_mul_f32 v8, v84, v56
    v_mul_f32 v12, v84, v60
    v_fma_f32 v8, -v100, v60, v8
    v_fma_f32 v12, v100, v56, v12
    v_mul_f32 v9, v85, v57
    v_mul_f32 v13, v85, v61
    v_fma_f32 v9, -v101, v61, v9
    v_fma_f32 v13, v101, v57, v13
    v_mul_f32 v10, v86, v58
    v_mul_f32 v14, v86, v62
    v_fma_f32 v10, -v102, v62, v10
    v_fma_f32 v14, v102, v58, v14
    v_mul_f32 v11, v87, v59
    v_mul_f32 v15, v87, v63
    v_fma_f32 v11, -v103, v63, v11
    v_fma_f32 v15, v103, v59, v15
    v_cvt_pk_bf16_f32 v66, v8, v9
    v_cvt_pk_bf16_f32 v67, v10, v11
    v_cvt_pk_bf16_f32 v70, v12, v13
    v_cvt_pk_bf16_f32 v71, v14, v15
    v_lshlrev_b32 v48, 16, v72
    v_and_b32 v52, 0xffff0000, v72
    v_lshlrev_b32 v49, 16, v73
    v_and_b32 v53, 0xffff0000, v73
    v_lshlrev_b32 v50, 16, v74
    v_and_b32 v54, 0xffff0000, v74
    v_lshlrev_b32 v51, 16, v75
    v_and_b32 v55, 0xffff0000, v75
    v_lshlrev_b32 v56, 16, v76
    v_and_b32 v60, 0xffff0000, v76
    v_lshlrev_b32 v57, 16, v77
    v_and_b32 v61, 0xffff0000, v77
    v_lshlrev_b32 v58, 16, v78
    v_and_b32 v62, 0xffff0000, v78
    v_lshlrev_b32 v59, 16, v79
    v_and_b32 v63, 0xffff0000, v79
    v_mul_f32 v8, v88, v48
    v_mul_f32 v12, v88, v52
    v_fma_f32 v8, -v104, v52, v8
    v_fma_f32 v12, v104, v48, v12
    v_mul_f32 v9, v89, v49
    v_mul_f32 v13, v89, v53
    v_fma_f32 v9, -v105, v53, v9
    v_fma_f32 v13, v105, v49, v13
    v_mul_f32 v10, v90, v50
    v_mul_f32 v14, v90, v54
    v_fma_f32 v10, -v106, v54, v10
    v_fma_f32 v14, v106, v50, v14
    v_mul_f32 v11, v91, v51
    v_mul_f32 v15, v91, v55
    v_fma_f32 v11, -v107, v55, v11
    v_fma_f32 v15, v107, v51, v15
    v_cvt_pk_bf16_f32 v72, v8, v9
    v_cvt_pk_bf16_f32 v73, v10, v11
    v_cvt_pk_bf16_f32 v76, v12, v13
    v_cvt_pk_bf16_f32 v77, v14, v15
    v_mul_f32 v8, v92, v56
    v_mul_f32 v12, v92, v60
    v_fma_f32 v8, -v108, v60, v8
    v_fma_f32 v12, v108, v56, v12
    v_mul_f32 v9, v93, v57
    v_mul_f32 v13, v93, v61
    v_fma_f32 v9, -v109, v61, v9
    v_fma_f32 v13, v109, v57, v13
    v_mul_f32 v10, v94, v58
    v_mul_f32 v14, v94, v62
    v_fma_f32 v10, -v110, v62, v10
    v_fma_f32 v14, v110, v58, v14
    v_mul_f32 v11, v95, v59
    v_mul_f32 v15, v95, v63
    v_fma_f32 v11, -v111, v63, v11
    v_fma_f32 v15, v111, v59, v15
    v_cvt_pk_bf16_f32 v74, v8, v9
    v_cvt_pk_bf16_f32 v75, v10, v11
    v_cvt_pk_bf16_f32 v78, v12, v13
    v_cvt_pk_bf16_f32 v79, v14, v15
    v_mul_u32_u24 v7, 576, v1
    v_lshl_add_u32 v7, v3, 2, v7
    v_add_u32 v7, s36, v7
    v_mul_u32_u24 v4, 144, v3
    v_lshl_add_u32 v4, v1, 4, v4
    v_add_u32 v4, s36, v4
    ds_read_b128 v[48:51], v5 offset:8192
    ds_read_b128 v[52:55], v5 offset:9216
    ds_read_b128 v[56:59], v5 offset:10240
    ds_read_b128 v[60:63], v5 offset:11264
    s_waitcnt lgkmcnt(0)
    v_mfma_f32_32x32x16_bf16 v[80:95], v[48:51], v[112:115], 0
    v_mfma_f32_32x32x16_bf16 v[80:95], v[52:55], v[120:123], v[80:95]
    v_mfma_f32_32x32x16_bf16 v[80:95], v[56:59], v[64:67], v[80:95]
    v_mfma_f32_32x32x16_bf16 v[80:95], v[60:63], v[72:75], v[80:95]
    v_mfma_f32_32x32x16_bf16 v[96:111], v[48:51], v[116:119], 0
    v_mfma_f32_32x32x16_bf16 v[96:111], v[52:55], v[124:127], v[96:111]
    v_mfma_f32_32x32x16_bf16 v[96:111], v[56:59], v[68:71], v[96:111]
    v_mfma_f32_32x32x16_bf16 v[96:111], v[60:63], v[76:79], v[96:111]
    ds_read_b128 v[48:51], v5 offset:12288
    ds_read_b128 v[52:55], v5 offset:13312
    ds_read_b128 v[56:59], v5 offset:14336
    ds_read_b128 v[60:63], v5 offset:15360
    s_waitcnt lgkmcnt(0)
    v_mfma_f32_32x32x16_bf16 v[80:95], v[48:51], v[116:119], v[80:95]
    v_mfma_f32_32x32x16_bf16 v[80:95], v[52:55], v[124:127], v[80:95]
    v_mfma_f32_32x32x16_bf16 v[80:95], v[56:59], v[68:71], v[80:95]
    v_mfma_f32_32x32x16_bf16 v[80:95], v[60:63], v[76:79], v[80:95]
    v_xor_b32 v112, 0x80008000, v112
    v_xor_b32 v113, 0x80008000, v113
    v_xor_b32 v114, 0x80008000, v114
    v_xor_b32 v115, 0x80008000, v115
    v_xor_b32 v120, 0x80008000, v120
    v_xor_b32 v121, 0x80008000, v121
    v_xor_b32 v122, 0x80008000, v122
    v_xor_b32 v123, 0x80008000, v123
    v_xor_b32 v64, 0x80008000, v64
    v_xor_b32 v65, 0x80008000, v65
    v_xor_b32 v66, 0x80008000, v66
    v_xor_b32 v67, 0x80008000, v67
    v_xor_b32 v72, 0x80008000, v72
    v_xor_b32 v73, 0x80008000, v73
    v_xor_b32 v74, 0x80008000, v74
    v_xor_b32 v75, 0x80008000, v75
    s_nop 1
    v_mfma_f32_32x32x16_bf16 v[96:111], v[48:51], v[112:115], v[96:111]
    v_mfma_f32_32x32x16_bf16 v[96:111], v[52:55], v[120:123], v[96:111]
    v_mfma_f32_32x32x16_bf16 v[96:111], v[56:59], v[64:67], v[96:111]
    v_mfma_f32_32x32x16_bf16 v[96:111], v[60:63], v[72:75], v[96:111]
    s_nop 7
    s_nop 3
    ds_read_b128 v[48:51], v5 offset:24576
    ds_read_b128 v[52:55], v5 offset:25600
    ds_read_b128 v[56:59], v5 offset:26624
    ds_read_b128 v[60:63], v5 offset:27648
    s_waitcnt lgkmcnt(0)
    v_mul_f32 v8, v80, v48
    v_mul_f32 v12, v96, v48
    v_fma_f32 v8, v96, v52, v8
    v_fma_f32 v12, -v80, v52, v12
    v_mul_f32 v9, v81, v49
    v_mul_f32 v13, v97, v49
    v_fma_f32 v9, v97, v53, v9
    v_fma_f32 v13, -v81, v53, v13
    v_mul_f32 v10, v82, v50
    v_mul_f32 v14, v98, v50
    v_fma_f32 v10, v98, v54, v10
    v_fma_f32 v14, -v82, v54, v14
    v_mul_f32 v11, v83, v51
    v_mul_f32 v15, v99, v51
    v_fma_f32 v11, v99, v55, v11
    v_fma_f32 v15, -v83, v55, v15
    ds_read_b128 v[48:51], v5 offset:28672
    ds_read_b128 v[52:55], v5 offset:29696
    v_cvt_pk_bf16_f32 v8, v12, v8
    ds_write_b32 v7, v8 offset:0
    v_cvt_pk_bf16_f32 v9, v13, v9
    ds_write_b32 v7, v9 offset:144
    v_cvt_pk_bf16_f32 v10, v14, v10
    ds_write_b32 v7, v10 offset:288
    v_cvt_pk_bf16_f32 v11, v15, v11
    ds_write_b32 v7, v11 offset:432
    s_waitcnt lgkmcnt(0)
    v_mul_f32 v8, v84, v56
    v_mul_f32 v12, v100, v56
    v_fma_f32 v8, v100, v60, v8
    v_fma_f32 v12, -v84, v60, v12
    v_mul_f32 v9, v85, v57
    v_mul_f32 v13, v101, v57
    v_fma_f32 v9, v101, v61, v9
    v_fma_f32 v13, -v85, v61, v13
    v_mul_f32 v10, v86, v58
    v_mul_f32 v14, v102, v58
    v_fma_f32 v10, v102, v62, v10
    v_fma_f32 v14, -v86, v62, v14
    v_mul_f32 v11, v87, v59
    v_mul_f32 v15, v103, v59
    v_fma_f32 v11, v103, v63, v11
    v_fma_f32 v15, -v87, v63, v15
    ds_read_b128 v[56:59], v5 offset:30720
    ds_read_b128 v[60:63], v5 offset:31744
    v_cvt_pk_bf16_f32 v8, v12, v8
    ds_write_b32 v7, v8 offset:1152
    v_cvt_pk_bf16_f32 v9, v13, v9
    ds_write_b32 v7, v9 offset:1296
    v_cvt_pk_bf16_f32 v10, v14, v10
    ds_write_b32 v7, v10 offset:1440
    v_cvt_pk_bf16_f32 v11, v15, v11
    ds_write_b32 v7, v11 offset:1584
    s_waitcnt lgkmcnt(0)
    v_mul_f32 v8, v88, v48
    v_mul_f32 v12, v104, v48
    v_fma_f32 v8, v104, v52, v8
    v_fma_f32 v12, -v88, v52, v12
    v_mul_f32 v9, v89, v49
    v_mul_f32 v13, v105, v49
    v_fma_f32 v9, v105, v53, v9
    v_fma_f32 v13, -v89, v53, v13
    v_mul_f32 v10, v90, v50
    v_mul_f32 v14, v106, v50
    v_fma_f32 v10, v106, v54, v10
    v_fma_f32 v14, -v90, v54, v14
    v_mul_f32 v11, v91, v51
    v_mul_f32 v15, v107, v51
    v_fma_f32 v11, v107, v55, v11
    v_fma_f32 v15, -v91, v55, v15
    v_cvt_pk_bf16_f32 v8, v12, v8
    ds_write_b32 v7, v8 offset:2304
    v_cvt_pk_bf16_f32 v9, v13, v9
    ds_write_b32 v7, v9 offset:2448
    v_cvt_pk_bf16_f32 v10, v14, v10
    ds_write_b32 v7, v10 offset:2592
    v_cvt_pk_bf16_f32 v11, v15, v11
    ds_write_b32 v7, v11 offset:2736
    s_waitcnt lgkmcnt(0)
    v_mul_f32 v8, v92, v56
    v_mul_f32 v12, v108, v56
    v_fma_f32 v8, v108, v60, v8
    v_fma_f32 v12, -v92, v60, v12
    v_mul_f32 v9, v93, v57
    v_mul_f32 v13, v109, v57
    v_fma_f32 v9, v109, v61, v9
    v_fma_f32 v13, -v93, v61, v13
    v_mul_f32 v10, v94, v58
    v_mul_f32 v14, v110, v58
    v_fma_f32 v10, v110, v62, v10
    v_fma_f32 v14, -v94, v62, v14
    v_mul_f32 v11, v95, v59
    v_mul_f32 v15, v111, v59
    v_fma_f32 v11, v111, v63, v11
    v_fma_f32 v15, -v95, v63, v15
    v_cvt_pk_bf16_f32 v8, v12, v8
    ds_write_b32 v7, v8 offset:3456
    v_cvt_pk_bf16_f32 v9, v13, v9
    ds_write_b32 v7, v9 offset:3600
    v_cvt_pk_bf16_f32 v10, v14, v10
    ds_write_b32 v7, v10 offset:3744
    v_cvt_pk_bf16_f32 v11, v15, v11
    ds_write_b32 v7, v11 offset:3888
    s_waitcnt lgkmcnt(0)
    ds_read_b128 v[16:19], v4 offset:0
    ds_read_b128 v[20:23], v4 offset:32
    ds_read_b128 v[24:27], v4 offset:64
    ds_read_b128 v[28:31], v4 offset:96
    ds_read_b128 v[48:51], v5 offset:4096
    ds_read_b128 v[52:55], v5 offset:5120
    ds_read_b128 v[56:59], v5 offset:6144
    ds_read_b128 v[60:63], v5 offset:7168
    s_waitcnt lgkmcnt(0)
    v_mfma_f32_32x32x16_bf16 v[80:95], v[48:51], v[16:19], 0
    v_mfma_f32_32x32x16_bf16 v[80:95], v[52:55], v[20:23], v[80:95]
    v_mfma_f32_32x32x16_bf16 v[80:95], v[56:59], v[24:27], v[80:95]
    v_mfma_f32_32x32x16_bf16 v[80:95], v[60:63], v[28:31], v[80:95]
    ds_read_b128 v[48:51], v5 offset:0
    ds_read_b128 v[52:55], v5 offset:1024
    ds_read_b128 v[56:59], v5 offset:2048
    ds_read_b128 v[60:63], v5 offset:3072
    s_waitcnt lgkmcnt(0)
    v_mfma_f32_32x32x16_bf16 v[96:111], v[48:51], v[16:19], 0
    v_mfma_f32_32x32x16_bf16 v[96:111], v[52:55], v[20:23], v[96:111]
    v_mfma_f32_32x32x16_bf16 v[96:111], v[56:59], v[24:27], v[96:111]
    v_mfma_f32_32x32x16_bf16 v[96:111], v[60:63], v[28:31], v[96:111]
    s_nop 7
    s_nop 3
    v_cvt_pk_bf16_f32 v32, v80, v96
    v_cvt_pk_bf16_f32 v33, v81, v97
    v_cvt_pk_bf16_f32 v34, v82, v98
    v_cvt_pk_bf16_f32 v35, v83, v99
    v_cvt_pk_bf16_f32 v36, v84, v100
    v_cvt_pk_bf16_f32 v37, v85, v101
    v_cvt_pk_bf16_f32 v38, v86, v102
    v_cvt_pk_bf16_f32 v39, v87, v103
    v_cvt_pk_bf16_f32 v40, v88, v104
    v_cvt_pk_bf16_f32 v41, v89, v105
    v_cvt_pk_bf16_f32 v42, v90, v106
    v_cvt_pk_bf16_f32 v43, v91, v107
    v_cvt_pk_bf16_f32 v44, v92, v108
    v_cvt_pk_bf16_f32 v45, v93, v109
    v_cvt_pk_bf16_f32 v46, v94, v110
    v_cvt_pk_bf16_f32 v47, v95, v111
    ds_read_b128 v[48:51], v5 offset:16384
    ds_read_b128 v[52:55], v5 offset:17408
    ds_read_b128 v[56:59], v5 offset:18432
    ds_read_b128 v[60:63], v5 offset:19456
    s_waitcnt lgkmcnt(0)
    v_mfma_f32_32x32x16_bf16 v[96:111], v[48:51], v[116:119], 0
    v_mfma_f32_32x32x16_bf16 v[96:111], v[52:55], v[124:127], v[96:111]
    v_mfma_f32_32x32x16_bf16 v[96:111], v[56:59], v[68:71], v[96:111]
    v_mfma_f32_32x32x16_bf16 v[96:111], v[60:63], v[76:79], v[96:111]
    v_xor_b32 v112, 0x80008000, v112
    v_xor_b32 v113, 0x80008000, v113
    v_xor_b32 v114, 0x80008000, v114
    v_xor_b32 v115, 0x80008000, v115
    v_xor_b32 v120, 0x80008000, v120
    v_xor_b32 v121, 0x80008000, v121
    v_xor_b32 v122, 0x80008000, v122
    v_xor_b32 v123, 0x80008000, v123
    v_xor_b32 v64, 0x80008000, v64
    v_xor_b32 v65, 0x80008000, v65
    v_xor_b32 v66, 0x80008000, v66
    v_xor_b32 v67, 0x80008000, v67
    v_xor_b32 v72, 0x80008000, v72
    v_xor_b32 v73, 0x80008000, v73
    v_xor_b32 v74, 0x80008000, v74
    v_xor_b32 v75, 0x80008000, v75
    s_nop 1
    v_mfma_f32_32x32x16_bf16 v[80:95], v[48:51], v[112:115], 0
    v_mfma_f32_32x32x16_bf16 v[80:95], v[52:55], v[120:123], v[80:95]
    v_mfma_f32_32x32x16_bf16 v[80:95], v[56:59], v[64:67], v[80:95]
    v_mfma_f32_32x32x16_bf16 v[80:95], v[60:63], v[72:75], v[80:95]
    ds_read_b128 v[48:51], v5 offset:20480
    ds_read_b128 v[52:55], v5 offset:21504
    ds_read_b128 v[56:59], v5 offset:22528
    ds_read_b128 v[60:63], v5 offset:23552
    s_waitcnt lgkmcnt(0)
    v_mfma_f32_32x32x16_bf16 v[80:95], v[48:51], v[116:119], v[80:95]
    v_mfma_f32_32x32x16_bf16 v[80:95], v[52:55], v[124:127], v[80:95]
    v_mfma_f32_32x32x16_bf16 v[80:95], v[56:59], v[68:71], v[80:95]
    v_mfma_f32_32x32x16_bf16 v[80:95], v[60:63], v[76:79], v[80:95]
    v_xor_b32 v112, 0x80008000, v112
    v_xor_b32 v113, 0x80008000, v113
    v_xor_b32 v114, 0x80008000, v114
    v_xor_b32 v115, 0x80008000, v115
    v_xor_b32 v120, 0x80008000, v120
    v_xor_b32 v121, 0x80008000, v121
    v_xor_b32 v122, 0x80008000, v122
    v_xor_b32 v123, 0x80008000, v123
    v_xor_b32 v64, 0x80008000, v64
    v_xor_b32 v65, 0x80008000, v65
    v_xor_b32 v66, 0x80008000, v66
    v_xor_b32 v67, 0x80008000, v67
    v_xor_b32 v72, 0x80008000, v72
    v_xor_b32 v73, 0x80008000, v73
    v_xor_b32 v74, 0x80008000, v74
    v_xor_b32 v75, 0x80008000, v75
    s_nop 1
    v_mfma_f32_32x32x16_bf16 v[96:111], v[48:51], v[112:115], v[96:111]
    v_mfma_f32_32x32x16_bf16 v[96:111], v[52:55], v[120:123], v[96:111]
    v_mfma_f32_32x32x16_bf16 v[96:111], v[56:59], v[64:67], v[96:111]
    v_mfma_f32_32x32x16_bf16 v[96:111], v[60:63], v[72:75], v[96:111]
    s_nop 7
    s_nop 3
    ds_read_b128 v[48:51], v5 offset:32768
    ds_read_b128 v[52:55], v5 offset:33792
    ds_read_b128 v[56:59], v5 offset:34816
    ds_read_b128 v[60:63], v5 offset:35840
    s_waitcnt lgkmcnt(0)
    v_mul_f32 v8, v80, v48
    v_mul_f32 v12, v96, v48
    v_fma_f32 v8, v96, v52, v8
    v_fma_f32 v12, -v80, v52, v12
    v_mul_f32 v9, v81, v49
    v_mul_f32 v13, v97, v49
    v_fma_f32 v9, v97, v53, v9
    v_fma_f32 v13, -v81, v53, v13
    v_mul_f32 v10, v82, v50
    v_mul_f32 v14, v98, v50
    v_fma_f32 v10, v98, v54, v10
    v_fma_f32 v14, -v82, v54, v14
    v_mul_f32 v11, v83, v51
    v_mul_f32 v15, v99, v51
    v_fma_f32 v11, v99, v55, v11
    v_fma_f32 v15, -v83, v55, v15
    ds_read_b128 v[48:51], v5 offset:36864
    ds_read_b128 v[52:55], v5 offset:37888
    v_cvt_pk_bf16_f32 v8, v12, v8
    ds_write_b32 v7, v8 offset:0
    v_cvt_pk_bf16_f32 v9, v13, v9
    ds_write_b32 v7, v9 offset:144
    v_cvt_pk_bf16_f32 v10, v14, v10
    ds_write_b32 v7, v10 offset:288
    v_cvt_pk_bf16_f32 v11, v15, v11
    ds_write_b32 v7, v11 offset:432
    s_waitcnt lgkmcnt(0)
    v_mul_f32 v8, v84, v56
    v_mul_f32 v12, v100, v56
    v_fma_f32 v8, v100, v60, v8
    v_fma_f32 v12, -v84, v60, v12
    v_mul_f32 v9, v85, v57
    v_mul_f32 v13, v101, v57
    v_fma_f32 v9, v101, v61, v9
    v_fma_f32 v13, -v85, v61, v13
    v_mul_f32 v10, v86, v58
    v_mul_f32 v14, v102, v58
    v_fma_f32 v10, v102, v62, v10
    v_fma_f32 v14, -v86, v62, v14
    v_mul_f32 v11, v87, v59
    v_mul_f32 v15, v103, v59
    v_fma_f32 v11, v103, v63, v11
    v_fma_f32 v15, -v87, v63, v15
    ds_read_b128 v[56:59], v5 offset:38912
    ds_read_b128 v[60:63], v5 offset:39936
    v_cvt_pk_bf16_f32 v8, v12, v8
    ds_write_b32 v7, v8 offset:1152
    v_cvt_pk_bf16_f32 v9, v13, v9
    ds_write_b32 v7, v9 offset:1296
    v_cvt_pk_bf16_f32 v10, v14, v10
    ds_write_b32 v7, v10 offset:1440
    v_cvt_pk_bf16_f32 v11, v15, v11
    ds_write_b32 v7, v11 offset:1584
    s_waitcnt lgkmcnt(0)
    v_mul_f32 v8, v88, v48
    v_mul_f32 v12, v104, v48
    v_fma_f32 v8, v104, v52, v8
    v_fma_f32 v12, -v88, v52, v12
    v_mul_f32 v9, v89, v49
    v_mul_f32 v13, v105, v49
    v_fma_f32 v9, v105, v53, v9
    v_fma_f32 v13, -v89, v53, v13
    v_mul_f32 v10, v90, v50
    v_mul_f32 v14, v106, v50
    v_fma_f32 v10, v106, v54, v10
    v_fma_f32 v14, -v90, v54, v14
    v_mul_f32 v11, v91, v51
    v_mul_f32 v15, v107, v51
    v_fma_f32 v11, v107, v55, v11
    v_fma_f32 v15, -v91, v55, v15
    v_cvt_pk_bf16_f32 v8, v12, v8
    ds_write_b32 v7, v8 offset:2304
    v_cvt_pk_bf16_f32 v9, v13, v9
    ds_write_b32 v7, v9 offset:2448
    v_cvt_pk_bf16_f32 v10, v14, v10
    ds_write_b32 v7, v10 offset:2592
    v_cvt_pk_bf16_f32 v11, v15, v11
    ds_write_b32 v7, v11 offset:2736
    s_waitcnt lgkmcnt(0)
    v_mul_f32 v8, v92, v56
    v_mul_f32 v12, v108, v56
    v_fma_f32 v8, v108, v60, v8
    v_fma_f32 v12, -v92, v60, v12
    v_mul_f32 v9, v93, v57
    v_mul_f32 v13, v109, v57
    v_fma_f32 v9, v109, v61, v9
    v_fma_f32 v13, -v93, v61, v13
    v_mul_f32 v10, v94, v58
    v_mul_f32 v14, v110, v58
    v_fma_f32 v10, v110, v62, v10
    v_fma_f32 v14, -v94, v62, v14
    v_mul_f32 v11, v95, v59
    v_mul_f32 v15, v111, v59
    v_fma_f32 v11, v111, v63, v11
    v_fma_f32 v15, -v95, v63, v15
    v_cvt_pk_bf16_f32 v8, v12, v8
    ds_write_b32 v7, v8 offset:3456
    v_cvt_pk_bf16_f32 v9, v13, v9
    ds_write_b32 v7, v9 offset:3600
    v_cvt_pk_bf16_f32 v10, v14, v10
    ds_write_b32 v7, v10 offset:3744
    v_cvt_pk_bf16_f32 v11, v15, v11
    ds_write_b32 v7, v11 offset:3888
    s_waitcnt lgkmcnt(0)
    ds_read_b128 v[16:19], v4 offset:0
    ds_read_b128 v[20:23], v4 offset:32
    ds_read_b128 v[24:27], v4 offset:64
    ds_read_b128 v[28:31], v4 offset:96
    ds_read_b128 v[48:51], v5 offset:4096
    ds_read_b128 v[52:55], v5 offset:5120
    ds_read_b128 v[56:59], v5 offset:6144
    ds_read_b128 v[60:63], v5 offset:7168
    s_waitcnt lgkmcnt(0)
    v_mfma_f32_32x32x16_bf16 v[80:95], v[48:51], v[16:19], 0
    v_mfma_f32_32x32x16_bf16 v[80:95], v[52:55], v[20:23], v[80:95]
    v_mfma_f32_32x32x16_bf16 v[80:95], v[56:59], v[24:27], v[80:95]
    v_mfma_f32_32x32x16_bf16 v[80:95], v[60:63], v[28:31], v[80:95]
    ds_read_b128 v[48:51], v5 offset:0
    ds_read_b128 v[52:55], v5 offset:1024
    ds_read_b128 v[56:59], v5 offset:2048
    ds_read_b128 v[60:63], v5 offset:3072
    s_waitcnt lgkmcnt(0)
    v_mfma_f32_32x32x16_bf16 v[96:111], v[48:51], v[16:19], 0
    v_mfma_f32_32x32x16_bf16 v[96:111], v[52:55], v[20:23], v[96:111]
    v_mfma_f32_32x32x16_bf16 v[96:111], v[56:59], v[24:27], v[96:111]
    v_mfma_f32_32x32x16_bf16 v[96:111], v[60:63], v[28:31], v[96:111]
    s_nop 7
    s_nop 3
    v_cvt_pk_bf16_f32 v16, v80, v96
    v_cvt_pk_bf16_f32 v17, v81, v97
    v_cvt_pk_bf16_f32 v18, v82, v98
    v_cvt_pk_bf16_f32 v19, v83, v99
    v_cvt_pk_bf16_f32 v20, v84, v100
    v_cvt_pk_bf16_f32 v21, v85, v101
    v_cvt_pk_bf16_f32 v22, v86, v102
    v_cvt_pk_bf16_f32 v23, v87, v103
    v_cvt_pk_bf16_f32 v24, v88, v104
    v_cvt_pk_bf16_f32 v25, v89, v105
    v_cvt_pk_bf16_f32 v26, v90, v106
    v_cvt_pk_bf16_f32 v27, v91, v107
    v_cvt_pk_bf16_f32 v28, v92, v108
    v_cvt_pk_bf16_f32 v29, v93, v109
    v_cvt_pk_bf16_f32 v30, v94, v110
    v_cvt_pk_bf16_f32 v31, v95, v111
    s_barrier
    s_lshl_b32 s37, s3, 2
    v_lshlrev_b32 v7, 12, v1
    v_lshl_add_u32 v7, v3, 4, v7
    v_add_u32 v7, s37, v7
    v_add_u32 v8, 16384, v7
    ds_write_b32 v7, v32 offset:0
    ds_write_b32 v7, v33 offset:1024
    ds_write_b32 v7, v34 offset:2048
    ds_write_b32 v7, v35 offset:3072
    ds_write_b32 v7, v36 offset:8192
    ds_write_b32 v7, v37 offset:9216
    ds_write_b32 v7, v38 offset:10240
    ds_write_b32 v7, v39 offset:11264
    ds_write_b32 v8, v40 offset:0
    ds_write_b32 v8, v41 offset:1024
    ds_write_b32 v8, v42 offset:2048
    ds_write_b32 v8, v43 offset:3072
    ds_write_b32 v8, v44 offset:8192
    ds_write_b32 v8, v45 offset:9216
    ds_write_b32 v8, v46 offset:10240
    ds_write_b32 v8, v47 offset:11264
    ds_write_b32 v7, v16 offset:512
    ds_write_b32 v7, v17 offset:1536
    ds_write_b32 v7, v18 offset:2560
    ds_write_b32 v7, v19 offset:3584
    ds_write_b32 v7, v20 offset:8704
    ds_write_b32 v7, v21 offset:9728
    ds_write_b32 v7, v22 offset:10752
    ds_write_b32 v7, v23 offset:11776
    ds_write_b32 v8, v24 offset:512
    ds_write_b32 v8, v25 offset:1536
    ds_write_b32 v8, v26 offset:2560
    ds_write_b32 v8, v27 offset:3584
    ds_write_b32 v8, v28 offset:8704
    ds_write_b32 v8, v29 offset:9728
    ds_write_b32 v8, v30 offset:10752
    ds_write_b32 v8, v31 offset:11776
    s_waitcnt lgkmcnt(0)
    s_barrier
    s_lshl_b32 s37, s3, 13
    v_add_u32 v7, s37, v5
    v_mul_u32_u24 v5, 37888, v1
    v_lshl_add_u32 v5, v3, 4, v5
    s_lshl_b32 s38, s3, 4
    s_mul_i32 s38, s38, 37
    s_lshr_b32 s39, s24, 1
    s_add_u32 s38, s38, s39
    s_lshl_b32 s38, s38, 10
    s_and_b32 s39, s24, 1
    s_lshl_b32 s39, s39, 9
    s_add_u32 s38, s38, s39
    s_add_u32 s38, s38, 7536640
    ds_read_b128 v[16:19], v7 offset:0
    ds_read_b128 v[20:23], v7 offset:1024
    ds_read_b128 v[24:27], v7 offset:2048
    ds_read_b128 v[28:31], v7 offset:3072
    ds_read_b128 v[32:35], v7 offset:4096
    ds_read_b128 v[36:39], v7 offset:5120
    ds_read_b128 v[40:43], v7 offset:6144
    ds_read_b128 v[44:47], v7 offset:7168
    s_waitcnt lgkmcnt(7)
    buffer_store_dwordx4 v[16:19], v5, s[8:11], s38 offen sc1
    s_add_u32 s38, s38, 75776
    s_waitcnt lgkmcnt(6)
    buffer_store_dwordx4 v[20:23], v5, s[8:11], s38 offen sc1
    s_add_u32 s38, s38, 75776
    s_waitcnt lgkmcnt(5)
    buffer_store_dwordx4 v[24:27], v5, s[8:11], s38 offen sc1
    s_add_u32 s38, s38, 75776
    s_waitcnt lgkmcnt(4)
    buffer_store_dwordx4 v[28:31], v5, s[8:11], s38 offen sc1
    s_add_u32 s38, s38, 75776
    s_waitcnt lgkmcnt(3)
    buffer_store_dwordx4 v[32:35], v5, s[8:11], s38 offen sc1
    s_add_u32 s38, s38, 75776
    s_waitcnt lgkmcnt(2)
    buffer_store_dwordx4 v[36:39], v5, s[8:11], s38 offen sc1
    s_add_u32 s38, s38, 75776
    s_waitcnt lgkmcnt(1)
    buffer_store_dwordx4 v[40:43], v5, s[8:11], s38 offen sc1
    s_add_u32 s38, s38, 75776
    s_waitcnt lgkmcnt(0)
    buffer_store_dwordx4 v[44:47], v5, s[8:11], s38 offen sc1
    s_add_u32 s38, s38, 75776
    s_waitcnt vmcnt(0)
    s_endpgm
K2_END:
    s_endpgm
.globl k3_kernel
.p2align 8
.type k3_kernel,@function
k3_kernel:
    s_cmp_ge_u32 s2, 576
    s_cbranch_scc1 K3_END
    s_load_dwordx2 s[6:7], s[0:1], 72
    s_load_dwordx2 s[4:5], s[0:1], 0
    s_load_dwordx2 s[20:21], s[0:1], 56
    s_and_b32 s24, s2, 7
    s_lshl_b32 s24, s24, 3
    s_bfe_u32 s25, s2, 0x30003
    s_add_u32 s24, s24, s25
    s_lshr_b32 s25, s2, 6
    v_lshrrev_b32 v3, 6, v0
    v_and_b32 v1, 63, v0
    v_lshlrev_b32 v1, 4, v1
    v_readfirstlane_b32 s3, v3
    s_waitcnt lgkmcnt(0)
    s_mov_b32 s8, s6
    s_mov_b32 s9, s7
    s_mov_b32 s10, 268435456
    s_mov_b32 s11, 0x00020000
    s_mov_b32 s12, s4
    s_mov_b32 s13, s5
    s_mov_b32 s14, 2359296
    s_mov_b32 s15, 0x00020000
    s_mov_b32 s16, s20
    s_mov_b32 s17, s21
    s_mov_b32 s18, 2359296
    s_mov_b32 s19, 0x00020000
    s_mul_i32 s26, s24, 37888
    s_add_u32 s26, s26, 7536640
    s_mul_i32 s27, s25, 75776
    s_add_u32 s27, s27, 9961472
    s_add_u32 s28, s27, 37888
    s_mul_i32 s29, s24, 18
    s_lshl_b32 s30, s25, 1
    s_add_u32 s29, s29, s30
    s_lshl_b32 s29, s29, 11
    s_add_u32 s29, s29, 36700160
    v_and_b32 v2, 31, v0
    v_bfe_u32 v3, v0, 5, 1
    s_lshl_b32 s30, s24, 5
    v_add_u32 v2, s30, v2
    v_mul_u32_u24 v2, 1152, v2
    v_lshl_add_u32 v2, v3, 4, v2
    s_lshl_b32 s30, s25, 7
    s_lshl_b32 s31, s3, 10
    s_add_u32 s26, s26, s31
    s_add_u32 s27, s27, s31
    s_add_u32 s28, s28, s31
    s_mul_i32 s31, s3, 4718592
    s_add_u32 s29, s29, s31
    s_lshr_b32 s31, s3, 1
    s_lshl_b32 s31, s31, 6
    s_add_u32 s30, s30, s31
    s_and_b32 s31, s3, 1
    s_lshl_b32 s31, s31, 5
    s_add_u32 s30, s30, s31
    s_cmp_lg_u32 s3, 0
    s_cbranch_scc1 K3_W9
    buffer_load_dwordx4 v[68:71], v1, s[8:11], s26 offen
    buffer_load_dwordx4 v[72:75], v1, s[8:11], s27 offen
    buffer_load_dwordx4 v[76:79], v1, s[8:11], s28 offen
    s_add_u32 s26, s26, 4096
    s_add_u32 s27, s27, 4096
    s_add_u32 s28, s28, 4096
    buffer_load_dwordx4 v[80:83], v1, s[8:11], s26 offen
    buffer_load_dwordx4 v[84:87], v1, s[8:11], s27 offen
    buffer_load_dwordx4 v[88:91], v1, s[8:11], s28 offen
    s_add_u32 s26, s26, 4096
    s_add_u32 s27, s27, 4096
    s_add_u32 s28, s28, 4096
    buffer_load_dwordx4 v[92:95], v1, s[8:11], s26 offen
    buffer_load_dwordx4 v[96:99], v1, s[8:11], s27 offen
    buffer_load_dwordx4 v[100:103], v1, s[8:11], s28 offen
    s_add_u32 s26, s26, 4096
    s_add_u32 s27, s27, 4096
    s_add_u32 s28, s28, 4096
    buffer_load_dwordx4 v[104:107], v1, s[8:11], s26 offen
    buffer_load_dwordx4 v[108:111], v1, s[8:11], s27 offen
    buffer_load_dwordx4 v[112:115], v1, s[8:11], s28 offen
    s_add_u32 s26, s26, 4096
    s_add_u32 s27, s27, 4096
    s_add_u32 s28, s28, 4096
    buffer_load_dwordx4 v[116:119], v1, s[8:11], s26 offen
    buffer_load_dwordx4 v[120:123], v1, s[8:11], s27 offen
    buffer_load_dwordx4 v[124:127], v1, s[8:11], s28 offen
    s_add_u32 s26, s26, 4096
    s_add_u32 s27, s27, 4096
    s_add_u32 s28, s28, 4096
    buffer_load_dwordx4 v[36:39], v1, s[8:11], s29 offen offset:0
    buffer_load_dwordx4 v[40:43], v1, s[8:11], s29 offen offset:1024
    buffer_load_dwordx4 v[44:47], v1, s[8:11], s29 offen offset:2048
    buffer_load_dwordx4 v[48:51], v1, s[8:11], s29 offen offset:3072
    s_add_u32 s29, s29, 2359296
    buffer_load_dwordx4 v[52:55], v1, s[8:11], s29 offen offset:0
    buffer_load_dwordx4 v[56:59], v1, s[8:11], s29 offen offset:1024
    buffer_load_dwordx4 v[60:63], v1, s[8:11], s29 offen offset:2048
    buffer_load_dwordx4 v[64:67], v1, s[8:11], s29 offen offset:3072
    s_waitcnt vmcnt(20)
    v_mfma_f32_32x32x16_bf16 v[4:19], v[72:75], v[68:71], 0
    v_mfma_f32_32x32x16_bf16 v[20:35], v[76:79], v[68:71], 0
    buffer_load_dwordx4 v[68:71], v1, s[8:11], s26 offen
    buffer_load_dwordx4 v[72:75], v1, s[8:11], s27 offen
    buffer_load_dwordx4 v[76:79], v1, s[8:11], s28 offen
    s_add_u32 s26, s26, 4096
    s_add_u32 s27, s27, 4096
    s_add_u32 s28, s28, 4096
    s_waitcnt vmcnt(20)
    v_mfma_f32_32x32x16_bf16 v[4:19], v[84:87], v[80:83], v[4:19]
    v_mfma_f32_32x32x16_bf16 v[20:35], v[88:91], v[80:83], v[20:35]
    buffer_load_dwordx4 v[80:83], v1, s[8:11], s26 offen
    buffer_load_dwordx4 v[84:87], v1, s[8:11], s27 offen
    buffer_load_dwordx4 v[88:91], v1, s[8:11], s28 offen
    s_add_u32 s26, s26, 4096
    s_add_u32 s27, s27, 4096
    s_add_u32 s28, s28, 4096
    s_waitcnt vmcnt(20)
    v_mfma_f32_32x32x16_bf16 v[4:19], v[96:99], v[92:95], v[4:19]
    v_mfma_f32_32x32x16_bf16 v[20:35], v[100:103], v[92:95], v[20:35]
    buffer_load_dwordx4 v[92:95], v1, s[8:11], s26 offen
    buffer_load_dwordx4 v[96:99], v1, s[8:11], s27 offen
    buffer_load_dwordx4 v[100:103], v1, s[8:11], s28 offen
    s_add_u32 s26, s26, 4096
    s_add_u32 s27, s27, 4096
    s_add_u32 s28, s28, 4096
    s_waitcnt vmcnt(20)
    v_mfma_f32_32x32x16_bf16 v[4:19], v[108:111], v[104:107], v[4:19]
    v_mfma_f32_32x32x16_bf16 v[20:35], v[112:115], v[104:107], v[20:35]
    buffer_load_dwordx4 v[104:107], v1, s[8:11], s26 offen
    buffer_load_dwordx4 v[108:111], v1, s[8:11], s27 offen
    buffer_load_dwordx4 v[112:115], v1, s[8:11], s28 offen
    s_add_u32 s26, s26, 4096
    s_add_u32 s27, s27, 4096
    s_add_u32 s28, s28, 4096
    s_waitcnt vmcnt(20)
    v_mfma_f32_32x32x16_bf16 v[4:19], v[120:123], v[116:119], v[4:19]
    v_mfma_f32_32x32x16_bf16 v[20:35], v[124:127], v[116:119], v[20:35]
    buffer_load_dwordx4 v[116:119], v1, s[8:11], s26 offen
    buffer_load_dwordx4 v[120:123], v1, s[8:11], s27 offen
    buffer_load_dwordx4 v[124:127], v1, s[8:11], s28 offen
    s_add_u32 s26, s26, 4096
    s_add_u32 s27, s27, 4096
    s_add_u32 s28, s28, 4096
    s_waitcnt vmcnt(12)
    v_mfma_f32_32x32x16_bf16 v[4:19], v[72:75], v[68:71], v[4:19]
    v_mfma_f32_32x32x16_bf16 v[20:35], v[76:79], v[68:71], v[20:35]
    s_waitcnt vmcnt(9)
    v_mfma_f32_32x32x16_bf16 v[4:19], v[84:87], v[80:83], v[4:19]
    v_mfma_f32_32x32x16_bf16 v[20:35], v[88:91], v[80:83], v[20:35]
    buffer_load_dwordx4 v[68:71], v2, s[12:15], s30 offen
    s_waitcnt vmcnt(7)
    v_mfma_f32_32x32x16_bf16 v[4:19], v[96:99], v[92:95], v[4:19]
    v_mfma_f32_32x32x16_bf16 v[20:35], v[100:103], v[92:95], v[20:35]
    s_waitcnt vmcnt(4)
    v_mfma_f32_32x32x16_bf16 v[4:19], v[108:111], v[104:107], v[4:19]
    v_mfma_f32_32x32x16_bf16 v[20:35], v[112:115], v[104:107], v[20:35]
    s_waitcnt vmcnt(1)
    v_mfma_f32_32x32x16_bf16 v[4:19], v[120:123], v[116:119], v[4:19]
    v_mfma_f32_32x32x16_bf16 v[20:35], v[124:127], v[116:119], v[20:35]
    s_nop 7
    s_nop 3
    s_waitcnt vmcnt(23)
    v_lshlrev_b32 v2, 16, v36
    v_and_b32 v3, 0xffff0000, v36
    v_add_f32 v4, v4, v2
    v_add_f32 v5, v5, v3
    v_lshlrev_b32 v2, 16, v37
    v_and_b32 v3, 0xffff0000, v37
    v_add_f32 v6, v6, v2
    v_add_f32 v7, v7, v3
    v_lshlrev_b32 v2, 16, v38
    v_and_b32 v3, 0xffff0000, v38
    v_add_f32 v8, v8, v2
    v_add_f32 v9, v9, v3
    v_lshlrev_b32 v2, 16, v39
    v_and_b32 v3, 0xffff0000, v39
    v_add_f32 v10, v10, v2
    v_add_f32 v11, v11, v3
    s_waitcnt vmcnt(22)
    v_lshlrev_b32 v2, 16, v40
    v_and_b32 v3, 0xffff0000, v40
    v_add_f32 v12, v12, v2
    v_add_f32 v13, v13, v3
    v_lshlrev_b32 v2, 16, v41
    v_and_b32 v3, 0xffff0000, v41
    v_add_f32 v14, v14, v2
    v_add_f32 v15, v15, v3
    v_lshlrev_b32 v2, 16, v42
    v_and_b32 v3, 0xffff0000, v42
    v_add_f32 v16, v16, v2
    v_add_f32 v17, v17, v3
    v_lshlrev_b32 v2, 16, v43
    v_and_b32 v3, 0xffff0000, v43
    v_add_f32 v18, v18, v2
    v_add_f32 v19, v19, v3
    s_waitcnt vmcnt(21)
    v_lshlrev_b32 v2, 16, v44
    v_and_b32 v3, 0xffff0000, v44
    v_add_f32 v20, v20, v2
    v_add_f32 v21, v21, v3
    v_lshlrev_b32 v2, 16, v45
    v_and_b32 v3, 0xffff0000, v45
    v_add_f32 v22, v22, v2
    v_add_f32 v23, v23, v3
    v_lshlrev_b32 v2, 16, v46
    v_and_b32 v3, 0xffff0000, v46
    v_add_f32 v24, v24, v2
    v_add_f32 v25, v25, v3
    v_lshlrev_b32 v2, 16, v47
    v_and_b32 v3, 0xffff0000, v47
    v_add_f32 v26, v26, v2
    v_add_f32 v27, v27, v3
    s_waitcnt vmcnt(20)
    v_lshlrev_b32 v2, 16, v48
    v_and_b32 v3, 0xffff0000, v48
    v_add_f32 v28, v28, v2
    v_add_f32 v29, v29, v3
    v_lshlrev_b32 v2, 16, v49
    v_and_b32 v3, 0xffff0000, v49
    v_add_f32 v30, v30, v2
    v_add_f32 v31, v31, v3
    v_lshlrev_b32 v2, 16, v50
    v_and_b32 v3, 0xffff0000, v50
    v_add_f32 v32, v32, v2
    v_add_f32 v33, v33, v3
    v_lshlrev_b32 v2, 16, v51
    v_and_b32 v3, 0xffff0000, v51
    v_add_f32 v34, v34, v2
    v_add_f32 v35, v35, v3
    s_waitcnt vmcnt(19)
    v_lshlrev_b32 v2, 16, v52
    v_and_b32 v3, 0xffff0000, v52
    v_add_f32 v4, v4, v2
    v_add_f32 v5, v5, v3
    v_lshlrev_b32 v2, 16, v53
    v_and_b32 v3, 0xffff0000, v53
    v_add_f32 v6, v6, v2
    v_add_f32 v7, v7, v3
    v_lshlrev_b32 v2, 16, v54
    v_and_b32 v3, 0xffff0000, v54
    v_add_f32 v8, v8, v2
    v_add_f32 v9, v9, v3
    v_lshlrev_b32 v2, 16, v55
    v_and_b32 v3, 0xffff0000, v55
    v_add_f32 v10, v10, v2
    v_add_f32 v11, v11, v3
    s_waitcnt vmcnt(18)
    v_lshlrev_b32 v2, 16, v56
    v_and_b32 v3, 0xffff0000, v56
    v_add_f32 v12, v12, v2
    v_add_f32 v13, v13, v3
    v_lshlrev_b32 v2, 16, v57
    v_and_b32 v3, 0xffff0000, v57
    v_add_f32 v14, v14, v2
    v_add_f32 v15, v15, v3
    v_lshlrev_b32 v2, 16, v58
    v_and_b32 v3, 0xffff0000, v58
    v_add_f32 v16, v16, v2
    v_add_f32 v17, v17, v3
    v_lshlrev_b32 v2, 16, v59
    v_and_b32 v3, 0xffff0000, v59
    v_add_f32 v18, v18, v2
    v_add_f32 v19, v19, v3
    s_waitcnt vmcnt(17)
    v_lshlrev_b32 v2, 16, v60
    v_and_b32 v3, 0xffff0000, v60
    v_add_f32 v20, v20, v2
    v_add_f32 v21, v21, v3
    v_lshlrev_b32 v2, 16, v61
    v_and_b32 v3, 0xffff0000, v61
    v_add_f32 v22, v22, v2
    v_add_f32 v23, v23, v3
    v_lshlrev_b32 v2, 16, v62
    v_and_b32 v3, 0xffff0000, v62
    v_add_f32 v24, v24, v2
    v_add_f32 v25, v25, v3
    v_lshlrev_b32 v2, 16, v63
    v_and_b32 v3, 0xffff0000, v63
    v_add_f32 v26, v26, v2
    v_add_f32 v27, v27, v3
    s_waitcnt vmcnt(16)
    v_lshlrev_b32 v2, 16, v64
    v_and_b32 v3, 0xffff0000, v64
    v_add_f32 v28, v28, v2
    v_add_f32 v29, v29, v3
    v_lshlrev_b32 v2, 16, v65
    v_and_b32 v3, 0xffff0000, v65
    v_add_f32 v30, v30, v2
    v_add_f32 v31, v31, v3
    v_lshlrev_b32 v2, 16, v66
    v_and_b32 v3, 0xffff0000, v66
    v_add_f32 v32, v32, v2
    v_add_f32 v33, v33, v3
    v_lshlrev_b32 v2, 16, v67
    v_and_b32 v3, 0xffff0000, v67
    v_add_f32 v34, v34, v2
    v_add_f32 v35, v35, v3
    s_waitcnt vmcnt(0)
    v_mov_b32 v36, v68
    v_mov_b32 v37, v69
    v_mov_b32 v38, v70
    v_mov_b32 v39, v71
    s_branch K3_RED
K3_W9:
    buffer_load_dwordx4 v[68:71], v1, s[8:11], s26 offen
    buffer_load_dwordx4 v[72:75], v1, s[8:11], s27 offen
    buffer_load_dwordx4 v[76:79], v1, s[8:11], s28 offen
    s_add_u32 s26, s26, 4096
    s_add_u32 s27, s27, 4096
    s_add_u32 s28, s28, 4096
    buffer_load_dwordx4 v[80:83], v1, s[8:11], s26 offen
    buffer_load_dwordx4 v[84:87], v1, s[8:11], s27 offen
    buffer_load_dwordx4 v[88:91], v1, s[8:11], s28 offen
    s_add_u32 s26, s26, 4096
    s_add_u32 s27, s27, 4096
    s_add_u32 s28, s28, 4096
    buffer_load_dwordx4 v[92:95], v1, s[8:11], s26 offen
    buffer_load_dwordx4 v[96:99], v1, s[8:11], s27 offen
    buffer_load_dwordx4 v[100:103], v1, s[8:11], s28 offen
    s_add_u32 s26, s26, 4096
    s_add_u32 s27, s27, 4096
    s_add_u32 s28, s28, 4096
    buffer_load_dwordx4 v[104:107], v1, s[8:11], s26 offen
    buffer_load_dwordx4 v[108:111], v1, s[8:11], s27 offen
    buffer_load_dwordx4 v[112:115], v1, s[8:11], s28 offen
    s_add_u32 s26, s26, 4096
    s_add_u32 s27, s27, 4096
    s_add_u32 s28, s28, 4096
    buffer_load_dwordx4 v[116:119], v1, s[8:11], s26 offen
    buffer_load_dwordx4 v[120:123], v1, s[8:11], s27 offen
    buffer_load_dwordx4 v[124:127], v1, s[8:11], s28 offen
    s_add_u32 s26, s26, 4096
    s_add_u32 s27, s27, 4096
    s_add_u32 s28, s28, 4096
    buffer_load_dwordx4 v[36:39], v1, s[8:11], s29 offen offset:0
    buffer_load_dwordx4 v[40:43], v1, s[8:11], s29 offen offset:1024
    buffer_load_dwordx4 v[44:47], v1, s[8:11], s29 offen offset:2048
    buffer_load_dwordx4 v[48:51], v1, s[8:11], s29 offen offset:3072
    s_add_u32 s29, s29, 2359296
    buffer_load_dwordx4 v[52:55], v1, s[8:11], s29 offen offset:0
    buffer_load_dwordx4 v[56:59], v1, s[8:11], s29 offen offset:1024
    buffer_load_dwordx4 v[60:63], v1, s[8:11], s29 offen offset:2048
    buffer_load_dwordx4 v[64:67], v1, s[8:11], s29 offen offset:3072
    s_waitcnt vmcnt(20)
    v_mfma_f32_32x32x16_bf16 v[4:19], v[72:75], v[68:71], 0
    v_mfma_f32_32x32x16_bf16 v[20:35], v[76:79], v[68:71], 0
    buffer_load_dwordx4 v[68:71], v1, s[8:11], s26 offen
    buffer_load_dwordx4 v[72:75], v1, s[8:11], s27 offen
    buffer_load_dwordx4 v[76:79], v1, s[8:11], s28 offen
    s_add_u32 s26, s26, 4096
    s_add_u32 s27, s27, 4096
    s_add_u32 s28, s28, 4096
    s_waitcnt vmcnt(20)
    v_mfma_f32_32x32x16_bf16 v[4:19], v[84:87], v[80:83], v[4:19]
    v_mfma_f32_32x32x16_bf16 v[20:35], v[88:91], v[80:83], v[20:35]
    buffer_load_dwordx4 v[80:83], v1, s[8:11], s26 offen
    buffer_load_dwordx4 v[84:87], v1, s[8:11], s27 offen
    buffer_load_dwordx4 v[88:91], v1, s[8:11], s28 offen
    s_add_u32 s26, s26, 4096
    s_add_u32 s27, s27, 4096
    s_add_u32 s28, s28, 4096
    s_waitcnt vmcnt(20)
    v_mfma_f32_32x32x16_bf16 v[4:19], v[96:99], v[92:95], v[4:19]
    v_mfma_f32_32x32x16_bf16 v[20:35], v[100:103], v[92:95], v[20:35]
    buffer_load_dwordx4 v[92:95], v1, s[8:11], s26 offen
    buffer_load_dwordx4 v[96:99], v1, s[8:11], s27 offen
    buffer_load_dwordx4 v[100:103], v1, s[8:11], s28 offen
    s_add_u32 s26, s26, 4096
    s_add_u32 s27, s27, 4096
    s_add_u32 s28, s28, 4096
    s_waitcnt vmcnt(20)
    v_mfma_f32_32x32x16_bf16 v[4:19], v[108:111], v[104:107], v[4:19]
    v_mfma_f32_32x32x16_bf16 v[20:35], v[112:115], v[104:107], v[20:35]
    buffer_load_dwordx4 v[104:107], v1, s[8:11], s26 offen
    buffer_load_dwordx4 v[108:111], v1, s[8:11], s27 offen
    buffer_load_dwordx4 v[112:115], v1, s[8:11], s28 offen
    s_add_u32 s26, s26, 4096
    s_add_u32 s27, s27, 4096
    s_add_u32 s28, s28, 4096
    s_waitcnt vmcnt(20)
    v_mfma_f32_32x32x16_bf16 v[4:19], v[120:123], v[116:119], v[4:19]
    v_mfma_f32_32x32x16_bf16 v[20:35], v[124:127], v[116:119], v[20:35]
    s_waitcnt vmcnt(9)
    v_mfma_f32_32x32x16_bf16 v[4:19], v[72:75], v[68:71], v[4:19]
    v_mfma_f32_32x32x16_bf16 v[20:35], v[76:79], v[68:71], v[20:35]
    buffer_load_dwordx4 v[116:119], v2, s[12:15], s30 offen
    s_waitcnt vmcnt(7)
    v_mfma_f32_32x32x16_bf16 v[4:19], v[84:87], v[80:83], v[4:19]
    v_mfma_f32_32x32x16_bf16 v[20:35], v[88:91], v[80:83], v[20:35]
    s_waitcnt vmcnt(4)
    v_mfma_f32_32x32x16_bf16 v[4:19], v[96:99], v[92:95], v[4:19]
    v_mfma_f32_32x32x16_bf16 v[20:35], v[100:103], v[92:95], v[20:35]
    s_waitcnt vmcnt(1)
    v_mfma_f32_32x32x16_bf16 v[4:19], v[108:111], v[104:107], v[4:19]
    v_mfma_f32_32x32x16_bf16 v[20:35], v[112:115], v[104:107], v[20:35]
    s_nop 7
    s_nop 3
    s_waitcnt vmcnt(20)
    v_lshlrev_b32 v2, 16, v36
    v_and_b32 v3, 0xffff0000, v36
    v_add_f32 v4, v4, v2
    v_add_f32 v5, v5, v3
    v_lshlrev_b32 v2, 16, v37
    v_and_b32 v3, 0xffff0000, v37
    v_add_f32 v6, v6, v2
    v_add_f32 v7, v7, v3
    v_lshlrev_b32 v2, 16, v38
    v_and_b32 v3, 0xffff0000, v38
    v_add_f32 v8, v8, v2
    v_add_f32 v9, v9, v3
    v_lshlrev_b32 v2, 16, v39
    v_and_b32 v3, 0xffff0000, v39
    v_add_f32 v10, v10, v2
    v_add_f32 v11, v11, v3
    s_waitcnt vmcnt(19)
    v_lshlrev_b32 v2, 16, v40
    v_and_b32 v3, 0xffff0000, v40
    v_add_f32 v12, v12, v2
    v_add_f32 v13, v13, v3
    v_lshlrev_b32 v2, 16, v41
    v_and_b32 v3, 0xffff0000, v41
    v_add_f32 v14, v14, v2
    v_add_f32 v15, v15, v3
    v_lshlrev_b32 v2, 16, v42
    v_and_b32 v3, 0xffff0000, v42
    v_add_f32 v16, v16, v2
    v_add_f32 v17, v17, v3
    v_lshlrev_b32 v2, 16, v43
    v_and_b32 v3, 0xffff0000, v43
    v_add_f32 v18, v18, v2
    v_add_f32 v19, v19, v3
    s_waitcnt vmcnt(18)
    v_lshlrev_b32 v2, 16, v44
    v_and_b32 v3, 0xffff0000, v44
    v_add_f32 v20, v20, v2
    v_add_f32 v21, v21, v3
    v_lshlrev_b32 v2, 16, v45
    v_and_b32 v3, 0xffff0000, v45
    v_add_f32 v22, v22, v2
    v_add_f32 v23, v23, v3
    v_lshlrev_b32 v2, 16, v46
    v_and_b32 v3, 0xffff0000, v46
    v_add_f32 v24, v24, v2
    v_add_f32 v25, v25, v3
    v_lshlrev_b32 v2, 16, v47
    v_and_b32 v3, 0xffff0000, v47
    v_add_f32 v26, v26, v2
    v_add_f32 v27, v27, v3
    s_waitcnt vmcnt(17)
    v_lshlrev_b32 v2, 16, v48
    v_and_b32 v3, 0xffff0000, v48
    v_add_f32 v28, v28, v2
    v_add_f32 v29, v29, v3
    v_lshlrev_b32 v2, 16, v49
    v_and_b32 v3, 0xffff0000, v49
    v_add_f32 v30, v30, v2
    v_add_f32 v31, v31, v3
    v_lshlrev_b32 v2, 16, v50
    v_and_b32 v3, 0xffff0000, v50
    v_add_f32 v32, v32, v2
    v_add_f32 v33, v33, v3
    v_lshlrev_b32 v2, 16, v51
    v_and_b32 v3, 0xffff0000, v51
    v_add_f32 v34, v34, v2
    v_add_f32 v35, v35, v3
    s_waitcnt vmcnt(16)
    v_lshlrev_b32 v2, 16, v52
    v_and_b32 v3, 0xffff0000, v52
    v_add_f32 v4, v4, v2
    v_add_f32 v5, v5, v3
    v_lshlrev_b32 v2, 16, v53
    v_and_b32 v3, 0xffff0000, v53
    v_add_f32 v6, v6, v2
    v_add_f32 v7, v7, v3
    v_lshlrev_b32 v2, 16, v54
    v_and_b32 v3, 0xffff0000, v54
    v_add_f32 v8, v8, v2
    v_add_f32 v9, v9, v3
    v_lshlrev_b32 v2, 16, v55
    v_and_b32 v3, 0xffff0000, v55
    v_add_f32 v10, v10, v2
    v_add_f32 v11, v11, v3
    s_waitcnt vmcnt(15)
    v_lshlrev_b32 v2, 16, v56
    v_and_b32 v3, 0xffff0000, v56
    v_add_f32 v12, v12, v2
    v_add_f32 v13, v13, v3
    v_lshlrev_b32 v2, 16, v57
    v_and_b32 v3, 0xffff0000, v57
    v_add_f32 v14, v14, v2
    v_add_f32 v15, v15, v3
    v_lshlrev_b32 v2, 16, v58
    v_and_b32 v3, 0xffff0000, v58
    v_add_f32 v16, v16, v2
    v_add_f32 v17, v17, v3
    v_lshlrev_b32 v2, 16, v59
    v_and_b32 v3, 0xffff0000, v59
    v_add_f32 v18, v18, v2
    v_add_f32 v19, v19, v3
    s_waitcnt vmcnt(14)
    v_lshlrev_b32 v2, 16, v60
    v_and_b32 v3, 0xffff0000, v60
    v_add_f32 v20, v20, v2
    v_add_f32 v21, v21, v3
    v_lshlrev_b32 v2, 16, v61
    v_and_b32 v3, 0xffff0000, v61
    v_add_f32 v22, v22, v2
    v_add_f32 v23, v23, v3
    v_lshlrev_b32 v2, 16, v62
    v_and_b32 v3, 0xffff0000, v62
    v_add_f32 v24, v24, v2
    v_add_f32 v25, v25, v3
    v_lshlrev_b32 v2, 16, v63
    v_and_b32 v3, 0xffff0000, v63
    v_add_f32 v26, v26, v2
    v_add_f32 v27, v27, v3
    s_waitcnt vmcnt(13)
    v_lshlrev_b32 v2, 16, v64
    v_and_b32 v3, 0xffff0000, v64
    v_add_f32 v28, v28, v2
    v_add_f32 v29, v29, v3
    v_lshlrev_b32 v2, 16, v65
    v_and_b32 v3, 0xffff0000, v65
    v_add_f32 v30, v30, v2
    v_add_f32 v31, v31, v3
    v_lshlrev_b32 v2, 16, v66
    v_and_b32 v3, 0xffff0000, v66
    v_add_f32 v32, v32, v2
    v_add_f32 v33, v33, v3
    v_lshlrev_b32 v2, 16, v67
    v_and_b32 v3, 0xffff0000, v67
    v_add_f32 v34, v34, v2
    v_add_f32 v35, v35, v3
    s_waitcnt vmcnt(0)
    v_mov_b32 v36, v116
    v_mov_b32 v37, v117
    v_mov_b32 v38, v118
    v_mov_b32 v39, v119
K3_RED:
    s_lshl_b32 s31, s3, 13
    v_add_u32 v2, s31, v1
    ds_write_b128 v2, v[4:7] offset:0
    ds_write_b128 v2, v[8:11] offset:1024
    ds_write_b128 v2, v[12:15] offset:2048
    ds_write_b128 v2, v[16:19] offset:3072
    ds_write_b128 v2, v[20:23] offset:4096
    ds_write_b128 v2, v[24:27] offset:5120
    ds_write_b128 v2, v[28:31] offset:6144
    ds_write_b128 v2, v[32:35] offset:7168
    s_lshl_b32 s31, s3, 11
    v_add_u32 v2, s31, v1
    s_waitcnt lgkmcnt(0)
    s_barrier
    ds_read_b128 v[40:43], v2 offset:0
    ds_read_b128 v[44:47], v2 offset:1024
    ds_read_b128 v[48:51], v2 offset:8192
    ds_read_b128 v[52:55], v2 offset:9216
    ds_read_b128 v[56:59], v2 offset:16384
    ds_read_b128 v[60:63], v2 offset:17408
    ds_read_b128 v[64:67], v2 offset:24576
    ds_read_b128 v[68:71], v2 offset:25600
    v_and_b32 v2, 31, v0
    v_bfe_u32 v3, v0, 5, 1
    s_lshl_b32 s31, s24, 5
    v_add_u32 v2, s31, v2
    v_mul_u32_u24 v2, 1152, v2
    v_lshl_add_u32 v2, v3, 4, v2
    v_lshlrev_b32 v4, 16, v36
    v_and_b32 v5, 0xffff0000, v36
    v_lshlrev_b32 v6, 16, v37
    v_and_b32 v7, 0xffff0000, v37
    v_lshlrev_b32 v8, 16, v38
    v_and_b32 v9, 0xffff0000, v38
    v_lshlrev_b32 v10, 16, v39
    v_and_b32 v11, 0xffff0000, v39
    s_waitcnt lgkmcnt(6)
    v_add_f32 v4, v4, v40
    v_add_f32 v5, v5, v41
    v_add_f32 v6, v6, v42
    v_add_f32 v7, v7, v43
    v_add_f32 v8, v8, v44
    v_add_f32 v9, v9, v45
    v_add_f32 v10, v10, v46
    v_add_f32 v11, v11, v47
    s_waitcnt lgkmcnt(4)
    v_add_f32 v4, v4, v48
    v_add_f32 v5, v5, v49
    v_add_f32 v6, v6, v50
    v_add_f32 v7, v7, v51
    v_add_f32 v8, v8, v52
    v_add_f32 v9, v9, v53
    v_add_f32 v10, v10, v54
    v_add_f32 v11, v11, v55
    s_waitcnt lgkmcnt(2)
    v_add_f32 v4, v4, v56
    v_add_f32 v5, v5, v57
    v_add_f32 v6, v6, v58
    v_add_f32 v7, v7, v59
    v_add_f32 v8, v8, v60
    v_add_f32 v9, v9, v61
    v_add_f32 v10, v10, v62
    v_add_f32 v11, v11, v63
    s_waitcnt lgkmcnt(0)
    v_add_f32 v4, v4, v64
    v_add_f32 v5, v5, v65
    v_add_f32 v6, v6, v66
    v_add_f32 v7, v7, v67
    v_add_f32 v8, v8, v68
    v_add_f32 v9, v9, v69
    v_add_f32 v10, v10, v70
    v_add_f32 v11, v11, v71
    v_cvt_pk_bf16_f32 v12, v4, v5
    v_cvt_pk_bf16_f32 v13, v6, v7
    v_cvt_pk_bf16_f32 v14, v8, v9
    v_cvt_pk_bf16_f32 v15, v10, v11
    buffer_store_dwordx4 v[12:15], v2, s[16:19], s30 offen
    s_waitcnt vmcnt(0)
K3_END:
    s_endpgm
.section .rodata,"a"
.p2align 6
.amdhsa_kernel k0_kernel
  .amdhsa_next_free_vgpr 244
  .amdhsa_next_free_sgpr 100
  .amdhsa_accum_offset 244
  .amdhsa_group_segment_fixed_size 0
  .amdhsa_kernarg_size 80
  .amdhsa_user_sgpr_count 2
  .amdhsa_user_sgpr_kernarg_segment_ptr 1
  .amdhsa_system_sgpr_workgroup_id_x 1
.end_amdhsa_kernel
.p2align 6
.amdhsa_kernel k1_kernel
  .amdhsa_next_free_vgpr 256
  .amdhsa_next_free_sgpr 100
  .amdhsa_accum_offset 256
  .amdhsa_group_segment_fixed_size 0
  .amdhsa_kernarg_size 80
  .amdhsa_user_sgpr_count 2
  .amdhsa_user_sgpr_kernarg_segment_ptr 1
  .amdhsa_system_sgpr_workgroup_id_x 1
.end_amdhsa_kernel
.p2align 6
.amdhsa_kernel k2_kernel
  .amdhsa_next_free_vgpr 128
  .amdhsa_next_free_sgpr 100
  .amdhsa_accum_offset 128
  .amdhsa_group_segment_fixed_size 0
  .amdhsa_kernarg_size 80
  .amdhsa_user_sgpr_count 2
  .amdhsa_user_sgpr_kernarg_segment_ptr 1
  .amdhsa_system_sgpr_workgroup_id_x 1
.end_amdhsa_kernel
.p2align 6
.amdhsa_kernel k3_kernel
  .amdhsa_next_free_vgpr 128
  .amdhsa_next_free_sgpr 100
  .amdhsa_accum_offset 128
  .amdhsa_group_segment_fixed_size 0
  .amdhsa_kernarg_size 80
  .amdhsa_user_sgpr_count 2
  .amdhsa_user_sgpr_kernarg_segment_ptr 1
  .amdhsa_system_sgpr_workgroup_id_x 1
.end_amdhsa_kernel
```
